```python
import torch

def _softmax(x, axis=-1):
    return torch.softmax(x, dim=axis)
def _gelu(x):
    return torch.nn.functional.gelu(x, approximate="tanh")
def _silu(x):
    return torch.nn.functional.silu(x)
def _sigmoid(x):
    return torch.sigmoid(x)
def _layernorm(x, axis=-1, eps=1e-5):
    m = x.mean(dim=axis, keepdim=True)
    v = x.var(dim=axis, keepdim=True, unbiased=False)
    return (x - m) / torch.sqrt(v + eps)
def _scatter_add(tgt, idx, src, axis=0):
    return tgt.clone().index_add_(axis, idx, src)
def _segment_sum(src, seg, n):
    out = torch.zeros((n,) + src.shape[1:], dtype=src.dtype)
    return out.index_add_(0, seg, src)
def _pad(x, pw):
    flat = tuple(v for pair in reversed(pw) for v in pair)
    return torch.nn.functional.pad(x, flat)

kernel_name = 'recurrent_scan__mha_block_cached__swiglu_ffn__decode'

def setup_inputs():

    _w = (lambda a: (lambda t: t.to(torch.bfloat16) if t.is_floating_point() else t)(torch.as_tensor(a)))
    def _A_setup():
        B, Sq, D = 2, 1, 640
        H, Sk, Dh = 32, 16384, 192
        return {
            "x": _w((lambda *s: torch.randn(*s, dtype=torch.bfloat16) * 0.05)(B, Sq, D)),
            "k_cache": _w((lambda *s: torch.randn(*s, dtype=torch.bfloat16) * 1.6)(B, H, Sk, Dh)),
            "v_cache": _w((lambda *s: torch.randn(*s, dtype=torch.bfloat16) * 0.2)(B, H, Sk, Dh)),
            "wq": _w((lambda *s: torch.randn(*s, dtype=torch.bfloat16) * 1.6)(D, H * Dh) * (D ** -0.5)),
            "wo": _w((lambda *s: torch.randn(*s, dtype=torch.bfloat16) * 0.2)(H * Dh, D) * ((H * Dh) ** -0.5)),
        }
    _A_in = _A_setup()

    def _B_setup():
        B, S, D, F = 2, 1, 640, 1536
        return {
            "x": _w((lambda *s: torch.randn(*s, dtype=torch.bfloat16) * 0.05)(B, S, D)),
            "w_gate": _w((lambda *s: torch.randn(*s, dtype=torch.bfloat16) * 0.1)(D, F)),
            "w_up": _w((lambda *s: torch.randn(*s, dtype=torch.bfloat16) * 0.1)(D, F)),
            "w_down": _w((lambda *s: torch.randn(*s, dtype=torch.bfloat16) * 0.1)(F, D)),
        }
    _B_in = _B_setup()

    return {
        "A_x": _A_in["x"],
        "A_k_cache": _A_in["k_cache"],
        "A_v_cache": _A_in["v_cache"],
        "A_wq": _A_in["wq"],
        "A_wo": _A_in["wo"],
        "B_x": _B_in["x"],
        "B_w_gate": _B_in["w_gate"],
        "B_w_up": _B_in["w_up"],
        "B_w_down": _B_in["w_down"],
    }

def reference(A_x, A_k_cache, A_v_cache, A_wq, A_wo, B_x, B_w_gate, B_w_up, B_w_down):
    def _A_ref(x, k_cache, v_cache, wq, wo):
        B, Sq, D = x.shape
        H, Dh = 32, 192
        q = (lambda x, *d: x.permute(*d))((x @ wq).reshape(B, Sq, H, Dh), 0, 2, 1, 3)
        scores = torch.einsum("bhqd,bhkd->bhqk", q, k_cache) * (Dh ** -0.5)
        p = _softmax(scores, axis=-1)
        o = torch.einsum("bhqk,bhkd->bhqd", p, v_cache)
        return (lambda x, *d: x.permute(*d))(o, 0, 2, 1, 3).reshape(B, Sq, H * Dh) @ wo

    def _B_ref(x, w_gate, w_up, w_down):
        g = _silu(x @ w_gate)
        u = x @ w_up
        return (g * u) @ w_down

    x = A_x
    xn = _layernorm(x, axis=-1)
    s = _A_ref(xn, A_k_cache, A_v_cache, A_wq, A_wo)
    g = _silu(_B_ref(xn, B_w_gate, B_w_up, B_w_down))
    return x + s * g
```

```asm
; @launch grid=(256,1,1) block=(320,1,1) lds=102400
.amdgcn_target "amdgcn-amd-amdhsa--gfx950"
.text
.globl recurrent_scan__mha_block_cached__swiglu_ffn__decode_kernel
.p2align 8
.type recurrent_scan__mha_block_cached__swiglu_ffn__decode_kernel,@function
recurrent_scan__mha_block_cached__swiglu_ffn__decode_kernel:
s_cmp_ge_u32 s2, 256
s_cbranch_scc1 L_end
s_load_dwordx16 s[4:19], s[0:1], 0
s_load_dwordx8 s[20:27], s[0:1], 64
v_lshrrev_b32 v1, 6, v0
v_and_b32 v0, 63, v0
s_lshr_b32 s48, s2, 3
v_readfirstlane_b32 s3, v1
s_and_b32 s49, s2, 7
s_mov_b32 s50, 0x3fb8aa3b
s_mov_b32 s51, 0x3d93cd3a
v_bfe_u32 v2, v0, 3, 1
v_mul_u32_u24 v2, 0x202, v2
v_add_u32 v2, 0x100, v2
v_or_b32 v3, 0x0c0c0000, v2
v_lshlrev_b32 v2, 16, v2
v_or_b32 v2, 0x0c0c, v2
v_and_b32 v4, 1, v0
v_cmp_eq_u32 vcc, 1, v4
s_nop 1
v_cndmask_b32 v2, v3, v2, vcc
v_bfe_u32 v4, v0, 1, 2
v_mov_b32 v3, 0x0c0c0c0c
v_cmp_eq_u32 vcc, 0, v4
s_nop 1
v_cndmask_b32 v20, v3, v2, vcc
v_cmp_eq_u32 vcc, 1, v4
s_nop 1
v_cndmask_b32 v21, v3, v2, vcc
v_cmp_eq_u32 vcc, 2, v4
s_nop 1
v_cndmask_b32 v22, v3, v2, vcc
v_cmp_eq_u32 vcc, 3, v4
s_nop 1
v_cndmask_b32 v23, v3, v2, vcc
s_lshr_b32 s67, s3, 1
v_bfe_u32 v6, v0, 2, 2
v_lshrrev_b32 v7, 4, v0
v_and_b32 v1, 3, v0
v_mul_u32_u24 v2, 384, v6
v_lshl_add_u32 v2, v7, 6, v2
v_lshl_add_u32 v2, v1, 4, v2
v_add_u32 v3, 3072, v2
v_lshrrev_b32 v60, 5, v0
v_lshl_add_u32 v60, v60, 2, v6
v_mul_u32_u24 v4, 384, v60
v_and_b32 v60, 1, v7
v_lshl_add_u32 v4, v60, 6, v4
v_lshl_add_u32 v4, v1, 4, v4
v_add_u32 v4, 256, v4
v_bfe_u32 v60, v0, 3, 1
v_lshl_add_u32 v60, v60, 2, v7
v_mul_u32_u24 v5, 384, v60
v_and_b32 v60, 7, v0
v_lshl_add_u32 v5, v60, 4, v5
s_and_b32 s52, s3, 1
s_lshl_b32 s53, s49, 1
s_add_u32 s52, s52, s53
s_mul_i32 s56, s52, 2
s_mov_b32 s71, 16
s_mov_b32 s99, 4294967295
s_mul_i32 s58, s56, 6144
s_lshl_b32 s64, s67, 5
s_add_u32 s64, s64, s48
s_mul_i32 s65, s64, 6291456
s_waitcnt lgkmcnt(0)
s_cmp_eq_u32 s3, 4
s_cbranch_scc1 L_helper
s_add_u32 s28, s6, s65
s_addc_u32 s29, s7, 0
s_and_b32 s29, s29, 0xffff
s_mov_b32 s30, 6291456
s_mov_b32 s31, 0x20000
buffer_load_dwordx4 v[72:75], v2, s[28:31], s58 offen nt
buffer_load_dwordx4 v[76:79], v2, s[28:31], s58 offen offset:1536 nt
buffer_load_dwordx4 v[80:83], v4, s[28:31], s58 offen nt
buffer_load_dwordx4 v[84:87], v3, s[28:31], s58 offen nt
buffer_load_dwordx4 v[88:91], v3, s[28:31], s58 offen offset:1536 nt
buffer_load_dwordx4 v[92:95], v4, s[28:31], s58 offen offset:3072 nt
s_add_u32 s32, s8, s65
s_addc_u32 s33, s9, 0
s_and_b32 s33, s33, 0xffff
s_mov_b32 s34, 6291456
s_mov_b32 s35, 0x20000
buffer_load_dwordx4 v[96:99], v5, s[32:35], s58 offen offset:0 nt
s_waitcnt vmcnt(6)
buffer_load_dwordx4 v[100:103], v5, s[32:35], s58 offen offset:128 nt
s_waitcnt vmcnt(6)
buffer_load_dwordx4 v[104:107], v5, s[32:35], s58 offen offset:256 nt
s_waitcnt vmcnt(6)
buffer_load_dwordx4 v[108:111], v5, s[32:35], s58 offen offset:3072 nt
s_waitcnt vmcnt(6)
buffer_load_dwordx4 v[112:115], v5, s[32:35], s58 offen offset:3200 nt
s_waitcnt vmcnt(6)
buffer_load_dwordx4 v[116:119], v5, s[32:35], s58 offen offset:3328 nt
s_waitcnt vmcnt(6)
s_add_u32 s58, s58, 6144
buffer_load_dwordx4 v[120:123], v2, s[28:31], s58 offen nt
s_waitcnt vmcnt(6)
buffer_load_dwordx4 v[124:127], v2, s[28:31], s58 offen offset:1536 nt
s_waitcnt vmcnt(6)
buffer_load_dwordx4 v[128:131], v4, s[28:31], s58 offen nt
s_waitcnt vmcnt(6)
buffer_load_dwordx4 v[132:135], v3, s[28:31], s58 offen nt
s_waitcnt vmcnt(6)
buffer_load_dwordx4 v[136:139], v3, s[28:31], s58 offen offset:1536 nt
s_waitcnt vmcnt(6)
buffer_load_dwordx4 v[140:143], v4, s[28:31], s58 offen offset:3072 nt
s_waitcnt vmcnt(6)
buffer_load_dwordx4 v[144:147], v5, s[32:35], s58 offen offset:0 nt
s_waitcnt vmcnt(6)
buffer_load_dwordx4 v[148:151], v5, s[32:35], s58 offen offset:128 nt
s_waitcnt vmcnt(6)
buffer_load_dwordx4 v[152:155], v5, s[32:35], s58 offen offset:256 nt
s_waitcnt vmcnt(6)
buffer_load_dwordx4 v[156:159], v5, s[32:35], s58 offen offset:3072 nt
s_waitcnt vmcnt(6)
buffer_load_dwordx4 v[160:163], v5, s[32:35], s58 offen offset:3200 nt
s_waitcnt vmcnt(6)
buffer_load_dwordx4 v[164:167], v5, s[32:35], s58 offen offset:3328 nt
s_waitcnt vmcnt(6)
s_add_u32 s58, s58, 190464
buffer_load_dwordx4 v[168:171], v2, s[28:31], s58 offen nt
s_waitcnt vmcnt(6)
buffer_load_dwordx4 v[172:175], v2, s[28:31], s58 offen offset:1536 nt
s_waitcnt vmcnt(6)
buffer_load_dwordx4 v[176:179], v4, s[28:31], s58 offen nt
s_waitcnt vmcnt(6)
buffer_load_dwordx4 v[180:183], v3, s[28:31], s58 offen nt
s_waitcnt vmcnt(6)
buffer_load_dwordx4 v[184:187], v3, s[28:31], s58 offen offset:1536 nt
s_waitcnt vmcnt(6)
buffer_load_dwordx4 v[188:191], v4, s[28:31], s58 offen offset:3072 nt
s_waitcnt vmcnt(6)
buffer_load_dwordx4 v[192:195], v5, s[32:35], s58 offen offset:0 nt
s_waitcnt vmcnt(6)
buffer_load_dwordx4 v[196:199], v5, s[32:35], s58 offen offset:128 nt
s_waitcnt vmcnt(6)
buffer_load_dwordx4 v[200:203], v5, s[32:35], s58 offen offset:256 nt
s_waitcnt vmcnt(6)
buffer_load_dwordx4 v[204:207], v5, s[32:35], s58 offen offset:3072 nt
s_waitcnt vmcnt(6)
buffer_load_dwordx4 v[208:211], v5, s[32:35], s58 offen offset:3200 nt
s_waitcnt vmcnt(6)
buffer_load_dwordx4 v[212:215], v5, s[32:35], s58 offen offset:3328 nt
s_waitcnt vmcnt(6)
s_mul_i32 s53, s64, 256
s_add_u32 s62, s26, s53
s_addc_u32 s63, s27, 0
s_mov_b32 s36, s26
s_and_b32 s37, s27, 0xffff
s_mov_b32 s38, 4194304
s_mov_b32 s39, 0x20000
s_mul_i32 s54, s3, 12288
s_add_u32 s54, s54, 4096
s_add_u32 s58, s58, 6144
s_add_u32 m0, s54, 0
s_nop 0
buffer_load_dwordx4 v2, s[28:31], s58 offen nt lds
s_waitcnt vmcnt(6)
s_add_u32 m0, s54, -512
s_nop 0
buffer_load_dwordx4 v2, s[28:31], s58 offen offset:1536 nt lds
s_waitcnt vmcnt(6)
s_add_u32 m0, s54, 2048
s_nop 0
buffer_load_dwordx4 v4, s[28:31], s58 offen nt lds
s_waitcnt vmcnt(6)
s_add_u32 m0, s54, 3072
s_nop 0
buffer_load_dwordx4 v3, s[28:31], s58 offen nt lds
s_waitcnt vmcnt(6)
s_add_u32 m0, s54, 2560
s_nop 0
buffer_load_dwordx4 v3, s[28:31], s58 offen offset:1536 nt lds
s_waitcnt vmcnt(6)
s_add_u32 m0, s54, 2048
s_nop 0
buffer_load_dwordx4 v4, s[28:31], s58 offen offset:3072 nt lds
s_waitcnt vmcnt(6)
s_add_u32 m0, s54, 6144
s_nop 0
buffer_load_dwordx4 v5, s[32:35], s58 offen offset:0 nt lds
s_waitcnt vmcnt(6)
s_add_u32 m0, s54, 7040
s_nop 0
buffer_load_dwordx4 v5, s[32:35], s58 offen offset:128 nt lds
s_waitcnt vmcnt(6)
s_add_u32 m0, s54, 7936
s_nop 0
buffer_load_dwordx4 v5, s[32:35], s58 offen offset:256 nt lds
s_waitcnt vmcnt(6)
s_add_u32 m0, s54, 6144
s_nop 0
buffer_load_dwordx4 v5, s[32:35], s58 offen offset:3072 nt lds
s_waitcnt vmcnt(6)
s_add_u32 m0, s54, 7040
s_nop 0
buffer_load_dwordx4 v5, s[32:35], s58 offen offset:3200 nt lds
s_waitcnt vmcnt(6)
s_add_u32 m0, s54, 7936
s_nop 0
buffer_load_dwordx4 v5, s[32:35], s58 offen offset:3328 nt lds
s_waitcnt vmcnt(6)
s_add_u32 s56, s56, 33
s_mov_b32 s71, 31
s_mov_b32 s99, 32
s_mov_b32 s57, 48
s_mov_b32 s59, 0
v_mov_b32 v24, 0
v_mov_b32 v25, 0
v_mov_b32 v26, 0
v_mov_b32 v27, 0
v_mov_b32 v28, 0
v_mov_b32 v29, 0
v_mov_b32 v30, 0
v_mov_b32 v31, 0
v_mov_b32 v32, 0
v_mov_b32 v33, 0
v_mov_b32 v34, 0
v_mov_b32 v35, 0
v_mov_b32 v56, 0xff800000
v_mov_b32 v57, 0
v_mov_b32 v58, 0
s_mul_i32 s52, s67, 384
s_add_u32 s52, s52, 2560
v_lshlrev_b32 v60, 6, v7
v_lshl_add_u32 v60, v1, 4, v60
v_add_u32 v60, s52, v60
v_and_b32 v61, 1, v7
v_lshlrev_b32 v61, 6, v61
v_lshl_add_u32 v61, v1, 4, v61
v_add_u32 v61, s52, v61
s_barrier
v_cmp_gt_u32 vcc, 32, v0
ds_read_b128 v[8:11], v60
ds_read_b128 v[12:15], v61 offset:256
s_waitcnt lgkmcnt(0)
v_cndmask_b32 v16, v12, v24, vcc
v_cndmask_b32 v17, v13, v24, vcc
v_cndmask_b32 v18, v14, v24, vcc
v_cndmask_b32 v19, v15, v24, vcc
v_cndmask_b32 v12, v24, v12, vcc
v_cndmask_b32 v13, v24, v13, vcc
v_cndmask_b32 v14, v24, v14, vcc
v_cndmask_b32 v15, v24, v15, vcc
s_waitcnt vmcnt(0)
v_mfma_f32_16x16x32_bf16 v[36:39], v[120:123], v[8:11], 0
v_mfma_f32_16x16x32_bf16 v[40:43], v[124:127], v[8:11], 0
v_mfma_f32_16x16x32_bf16 v[44:47], v[132:135], v[8:11], 0
v_mfma_f32_16x16x32_bf16 v[48:51], v[136:139], v[8:11], 0
v_mfma_f32_16x16x32_bf16 v[36:39], v[128:131], v[12:15], v[36:39]
v_mfma_f32_16x16x32_bf16 v[40:43], v[128:131], v[16:19], v[40:43]
v_mfma_f32_16x16x32_bf16 v[44:47], v[140:143], v[12:15], v[44:47]
v_mfma_f32_16x16x32_bf16 v[48:51], v[140:143], v[16:19], v[48:51]
s_nop 4
v_mov_b32_dpp v52, v36 quad_perm:[0,0,0,0] row_mask:0xf bank_mask:0xf
v_add_f32_dpp v52, v37, v52 quad_perm:[1,1,1,1] row_mask:0xf bank_mask:0xf
v_add_f32_dpp v52, v38, v52 quad_perm:[2,2,2,2] row_mask:0xf bank_mask:0xf
v_add_f32_dpp v52, v39, v52 quad_perm:[3,3,3,3] row_mask:0xf bank_mask:0xf
v_mov_b32_dpp v53, v40 quad_perm:[0,0,0,0] row_mask:0xf bank_mask:0xf
v_add_f32_dpp v53, v41, v53 quad_perm:[1,1,1,1] row_mask:0xf bank_mask:0xf
v_add_f32_dpp v53, v42, v53 quad_perm:[2,2,2,2] row_mask:0xf bank_mask:0xf
v_add_f32_dpp v53, v43, v53 quad_perm:[3,3,3,3] row_mask:0xf bank_mask:0xf
v_mov_b32_dpp v54, v44 quad_perm:[0,0,0,0] row_mask:0xf bank_mask:0xf
v_add_f32_dpp v54, v45, v54 quad_perm:[1,1,1,1] row_mask:0xf bank_mask:0xf
v_add_f32_dpp v54, v46, v54 quad_perm:[2,2,2,2] row_mask:0xf bank_mask:0xf
v_add_f32_dpp v54, v47, v54 quad_perm:[3,3,3,3] row_mask:0xf bank_mask:0xf
v_mov_b32_dpp v55, v48 quad_perm:[0,0,0,0] row_mask:0xf bank_mask:0xf
v_add_f32_dpp v55, v49, v55 quad_perm:[1,1,1,1] row_mask:0xf bank_mask:0xf
v_add_f32_dpp v55, v50, v55 quad_perm:[2,2,2,2] row_mask:0xf bank_mask:0xf
v_add_f32_dpp v55, v51, v55 quad_perm:[3,3,3,3] row_mask:0xf bank_mask:0xf
v_cvt_pk_bf16_f32 v62, v52, v53
v_cvt_pk_bf16_f32 v63, v54, v55
v_lshlrev_b32 v52, 16, v62
v_and_b32 v53, 0xffff0000, v62
v_lshlrev_b32 v54, 16, v63
v_and_b32 v55, 0xffff0000, v63
v_mul_f32 v52, s51, v52
v_mul_f32 v53, s51, v53
v_mul_f32 v54, s51, v54
v_mul_f32 v55, s51, v55
v_cvt_pk_bf16_f32 v62, v52, v53
v_cvt_pk_bf16_f32 v63, v54, v55
v_lshlrev_b32 v52, 16, v62
v_and_b32 v53, 0xffff0000, v62
v_lshlrev_b32 v54, 16, v63
v_and_b32 v55, 0xffff0000, v63
v_max3_f32 v59, v52, v53, v54
v_max_f32 v59, v59, v55
v_cmp_gt_f32 vcc, v59, v56
s_cbranch_vccnz L_rescale_1
L_back_2:
v_fma_f32 v52, v52, s50, v57
v_fma_f32 v53, v53, s50, v57
v_fma_f32 v54, v54, s50, v57
v_fma_f32 v55, v55, s50, v57
v_exp_f32 v52, v52
v_exp_f32 v53, v53
v_exp_f32 v54, v54
v_exp_f32 v55, v55
s_nop 0
v_cvt_pk_bf16_f32 v62, v52, v53
v_cvt_pk_bf16_f32 v63, v54, v55
v_add_f32 v60, v52, v53
v_add_f32 v61, v54, v55
v_perm_b32 v64, v62, v62, v20
v_perm_b32 v65, v62, v62, v21
v_perm_b32 v66, v62, v62, v22
v_perm_b32 v67, v62, v62, v23
v_perm_b32 v68, v63, v63, v20
v_perm_b32 v69, v63, v63, v21
v_perm_b32 v70, v63, v63, v22
v_perm_b32 v71, v63, v63, v23
v_add_f32 v60, v60, v61
v_add_f32 v58, v58, v60
s_nop 0
v_mfma_f32_16x16x32_bf16 v[24:27], v[64:67], v[144:147], v[24:27]
v_mfma_f32_16x16x32_bf16 v[28:31], v[64:67], v[148:151], v[28:31]
v_mfma_f32_16x16x32_bf16 v[32:35], v[64:67], v[152:155], v[32:35]
v_mfma_f32_16x16x32_bf16 v[24:27], v[68:71], v[156:159], v[24:27]
v_mfma_f32_16x16x32_bf16 v[28:31], v[68:71], v[160:163], v[28:31]
v_mfma_f32_16x16x32_bf16 v[32:35], v[68:71], v[164:167], v[32:35]
v_mfma_f32_16x16x32_bf16 v[36:39], v[72:75], v[8:11], 0
v_mfma_f32_16x16x32_bf16 v[40:43], v[76:79], v[8:11], 0
v_mfma_f32_16x16x32_bf16 v[44:47], v[84:87], v[8:11], 0
v_mfma_f32_16x16x32_bf16 v[48:51], v[88:91], v[8:11], 0
v_mfma_f32_16x16x32_bf16 v[36:39], v[80:83], v[12:15], v[36:39]
v_mfma_f32_16x16x32_bf16 v[40:43], v[80:83], v[16:19], v[40:43]
v_mfma_f32_16x16x32_bf16 v[44:47], v[92:95], v[12:15], v[44:47]
v_mfma_f32_16x16x32_bf16 v[48:51], v[92:95], v[16:19], v[48:51]
s_cmp_eq_u32 s57, 0
s_cbranch_scc1 L_new_3
s_add_u32 s56, s56, s71
s_sub_u32 s57, s57, 1
s_sub_u32 s71, s99, s71
s_branch L_have_4
L_new_3:
s_waitcnt lgkmcnt(0)
s_mov_b32 s71, 1
s_mov_b32 s99, 2
s_cmp_lt_u32 s60, 56
s_cselect_b32 s57, 1, 0
s_cmp_lt_u32 s60, 24
s_cselect_b32 s57, 3, s57
s_min_u32 s56, s60, 56
s_add_u32 s56, s56, s60
s_min_u32 s55, s60, 24
s_lshl_b32 s55, s55, 1
s_add_u32 s56, s56, s55
s_add_u32 s56, s56, 832
s_cmp_lt_u32 s56, 1024
s_cbranch_scc1 L_more_5
s_mov_b32 s59, 1
v_mov_b32 v60, 3584
ds_write_b32 v60, v60
s_branch L_nok_6
L_more_5:
L_have_4:
s_mul_i32 s58, s56, 6144
buffer_load_dwordx4 v[72:75], v2, s[28:31], s58 offen nt
buffer_load_dwordx4 v[76:79], v2, s[28:31], s58 offen offset:1536 nt
buffer_load_dwordx4 v[80:83], v4, s[28:31], s58 offen nt
buffer_load_dwordx4 v[84:87], v3, s[28:31], s58 offen nt
buffer_load_dwordx4 v[88:91], v3, s[28:31], s58 offen offset:1536 nt
buffer_load_dwordx4 v[92:95], v4, s[28:31], s58 offen offset:3072 nt
L_nok_6:
v_mov_b32_dpp v52, v36 quad_perm:[0,0,0,0] row_mask:0xf bank_mask:0xf
v_add_f32_dpp v52, v37, v52 quad_perm:[1,1,1,1] row_mask:0xf bank_mask:0xf
v_add_f32_dpp v52, v38, v52 quad_perm:[2,2,2,2] row_mask:0xf bank_mask:0xf
v_add_f32_dpp v52, v39, v52 quad_perm:[3,3,3,3] row_mask:0xf bank_mask:0xf
v_mov_b32_dpp v53, v40 quad_perm:[0,0,0,0] row_mask:0xf bank_mask:0xf
v_add_f32_dpp v53, v41, v53 quad_perm:[1,1,1,1] row_mask:0xf bank_mask:0xf
v_add_f32_dpp v53, v42, v53 quad_perm:[2,2,2,2] row_mask:0xf bank_mask:0xf
v_add_f32_dpp v53, v43, v53 quad_perm:[3,3,3,3] row_mask:0xf bank_mask:0xf
v_mov_b32_dpp v54, v44 quad_perm:[0,0,0,0] row_mask:0xf bank_mask:0xf
v_add_f32_dpp v54, v45, v54 quad_perm:[1,1,1,1] row_mask:0xf bank_mask:0xf
v_add_f32_dpp v54, v46, v54 quad_perm:[2,2,2,2] row_mask:0xf bank_mask:0xf
v_add_f32_dpp v54, v47, v54 quad_perm:[3,3,3,3] row_mask:0xf bank_mask:0xf
v_mov_b32_dpp v55, v48 quad_perm:[0,0,0,0] row_mask:0xf bank_mask:0xf
v_add_f32_dpp v55, v49, v55 quad_perm:[1,1,1,1] row_mask:0xf bank_mask:0xf
v_add_f32_dpp v55, v50, v55 quad_perm:[2,2,2,2] row_mask:0xf bank_mask:0xf
v_add_f32_dpp v55, v51, v55 quad_perm:[3,3,3,3] row_mask:0xf bank_mask:0xf
v_cvt_pk_bf16_f32 v62, v52, v53
v_cvt_pk_bf16_f32 v63, v54, v55
v_lshlrev_b32 v52, 16, v62
v_and_b32 v53, 0xffff0000, v62
v_lshlrev_b32 v54, 16, v63
v_and_b32 v55, 0xffff0000, v63
v_mul_f32 v52, s51, v52
v_mul_f32 v53, s51, v53
v_mul_f32 v54, s51, v54
v_mul_f32 v55, s51, v55
v_cvt_pk_bf16_f32 v62, v52, v53
v_cvt_pk_bf16_f32 v63, v54, v55
v_lshlrev_b32 v52, 16, v62
v_and_b32 v53, 0xffff0000, v62
v_lshlrev_b32 v54, 16, v63
v_and_b32 v55, 0xffff0000, v63
v_max3_f32 v59, v52, v53, v54
v_max_f32 v59, v59, v55
v_cmp_gt_f32 vcc, v59, v56
s_cbranch_vccnz L_rescale_7
L_back_8:
v_fma_f32 v52, v52, s50, v57
v_fma_f32 v53, v53, s50, v57
v_fma_f32 v54, v54, s50, v57
v_fma_f32 v55, v55, s50, v57
v_exp_f32 v52, v52
v_exp_f32 v53, v53
v_exp_f32 v54, v54
v_exp_f32 v55, v55
s_nop 0
v_cvt_pk_bf16_f32 v62, v52, v53
v_cvt_pk_bf16_f32 v63, v54, v55
v_add_f32 v60, v52, v53
v_add_f32 v61, v54, v55
v_perm_b32 v64, v62, v62, v20
v_perm_b32 v65, v62, v62, v21
v_perm_b32 v66, v62, v62, v22
v_perm_b32 v67, v62, v62, v23
v_perm_b32 v68, v63, v63, v20
v_perm_b32 v69, v63, v63, v21
v_perm_b32 v70, v63, v63, v22
v_perm_b32 v71, v63, v63, v23
v_add_f32 v60, v60, v61
v_add_f32 v58, v58, v60
s_nop 0
v_mfma_f32_16x16x32_bf16 v[24:27], v[64:67], v[96:99], v[24:27]
v_mfma_f32_16x16x32_bf16 v[28:31], v[64:67], v[100:103], v[28:31]
v_mfma_f32_16x16x32_bf16 v[32:35], v[64:67], v[104:107], v[32:35]
v_mfma_f32_16x16x32_bf16 v[24:27], v[68:71], v[108:111], v[24:27]
v_mfma_f32_16x16x32_bf16 v[28:31], v[68:71], v[112:115], v[28:31]
v_mfma_f32_16x16x32_bf16 v[32:35], v[68:71], v[116:119], v[32:35]
s_cmp_eq_u32 s59, 0
s_cbranch_scc0 L_nov_9
buffer_load_dwordx4 v[96:99], v5, s[32:35], s58 offen offset:0 nt
buffer_load_dwordx4 v[100:103], v5, s[32:35], s58 offen offset:128 nt
buffer_load_dwordx4 v[104:107], v5, s[32:35], s58 offen offset:256 nt
buffer_load_dwordx4 v[108:111], v5, s[32:35], s58 offen offset:3072 nt
buffer_load_dwordx4 v[112:115], v5, s[32:35], s58 offen offset:3200 nt
buffer_load_dwordx4 v[116:119], v5, s[32:35], s58 offen offset:3328 nt
s_cmp_eq_u32 s57, 0
s_cbranch_scc0 L_nov_9
s_mov_b32 s60, 1
s_atomic_add s60, s[62:63], 0x0 glc
L_nov_9:
v_mfma_f32_16x16x32_bf16 v[36:39], v[168:171], v[8:11], 0
v_mfma_f32_16x16x32_bf16 v[40:43], v[172:175], v[8:11], 0
v_mfma_f32_16x16x32_bf16 v[44:47], v[180:183], v[8:11], 0
v_mfma_f32_16x16x32_bf16 v[48:51], v[184:187], v[8:11], 0
v_mfma_f32_16x16x32_bf16 v[36:39], v[176:179], v[12:15], v[36:39]
v_mfma_f32_16x16x32_bf16 v[40:43], v[176:179], v[16:19], v[40:43]
v_mfma_f32_16x16x32_bf16 v[44:47], v[188:191], v[12:15], v[44:47]
v_mfma_f32_16x16x32_bf16 v[48:51], v[188:191], v[16:19], v[48:51]
s_nop 4
v_mov_b32_dpp v52, v36 quad_perm:[0,0,0,0] row_mask:0xf bank_mask:0xf
v_add_f32_dpp v52, v37, v52 quad_perm:[1,1,1,1] row_mask:0xf bank_mask:0xf
v_add_f32_dpp v52, v38, v52 quad_perm:[2,2,2,2] row_mask:0xf bank_mask:0xf
v_add_f32_dpp v52, v39, v52 quad_perm:[3,3,3,3] row_mask:0xf bank_mask:0xf
v_mov_b32_dpp v53, v40 quad_perm:[0,0,0,0] row_mask:0xf bank_mask:0xf
v_add_f32_dpp v53, v41, v53 quad_perm:[1,1,1,1] row_mask:0xf bank_mask:0xf
v_add_f32_dpp v53, v42, v53 quad_perm:[2,2,2,2] row_mask:0xf bank_mask:0xf
v_add_f32_dpp v53, v43, v53 quad_perm:[3,3,3,3] row_mask:0xf bank_mask:0xf
v_mov_b32_dpp v54, v44 quad_perm:[0,0,0,0] row_mask:0xf bank_mask:0xf
v_add_f32_dpp v54, v45, v54 quad_perm:[1,1,1,1] row_mask:0xf bank_mask:0xf
v_add_f32_dpp v54, v46, v54 quad_perm:[2,2,2,2] row_mask:0xf bank_mask:0xf
v_add_f32_dpp v54, v47, v54 quad_perm:[3,3,3,3] row_mask:0xf bank_mask:0xf
v_mov_b32_dpp v55, v48 quad_perm:[0,0,0,0] row_mask:0xf bank_mask:0xf
v_add_f32_dpp v55, v49, v55 quad_perm:[1,1,1,1] row_mask:0xf bank_mask:0xf
v_add_f32_dpp v55, v50, v55 quad_perm:[2,2,2,2] row_mask:0xf bank_mask:0xf
v_add_f32_dpp v55, v51, v55 quad_perm:[3,3,3,3] row_mask:0xf bank_mask:0xf
v_cvt_pk_bf16_f32 v62, v52, v53
v_cvt_pk_bf16_f32 v63, v54, v55
v_lshlrev_b32 v52, 16, v62
v_and_b32 v53, 0xffff0000, v62
v_lshlrev_b32 v54, 16, v63
v_and_b32 v55, 0xffff0000, v63
v_mul_f32 v52, s51, v52
v_mul_f32 v53, s51, v53
v_mul_f32 v54, s51, v54
v_mul_f32 v55, s51, v55
v_cvt_pk_bf16_f32 v62, v52, v53
v_cvt_pk_bf16_f32 v63, v54, v55
v_lshlrev_b32 v52, 16, v62
v_and_b32 v53, 0xffff0000, v62
v_lshlrev_b32 v54, 16, v63
v_and_b32 v55, 0xffff0000, v63
v_max3_f32 v59, v52, v53, v54
v_max_f32 v59, v59, v55
v_cmp_gt_f32 vcc, v59, v56
s_cbranch_vccnz L_rescale_10
L_back_11:
v_fma_f32 v52, v52, s50, v57
v_fma_f32 v53, v53, s50, v57
v_fma_f32 v54, v54, s50, v57
v_fma_f32 v55, v55, s50, v57
v_exp_f32 v52, v52
v_exp_f32 v53, v53
v_exp_f32 v54, v54
v_exp_f32 v55, v55
s_nop 0
v_cvt_pk_bf16_f32 v62, v52, v53
v_cvt_pk_bf16_f32 v63, v54, v55
v_add_f32 v60, v52, v53
v_add_f32 v61, v54, v55
v_perm_b32 v64, v62, v62, v20
v_perm_b32 v65, v62, v62, v21
v_perm_b32 v66, v62, v62, v22
v_perm_b32 v67, v62, v62, v23
v_perm_b32 v68, v63, v63, v20
v_perm_b32 v69, v63, v63, v21
v_perm_b32 v70, v63, v63, v22
v_perm_b32 v71, v63, v63, v23
v_add_f32 v60, v60, v61
v_add_f32 v58, v58, v60
s_nop 0
v_mfma_f32_16x16x32_bf16 v[24:27], v[64:67], v[192:195], v[24:27]
v_mfma_f32_16x16x32_bf16 v[28:31], v[64:67], v[196:199], v[28:31]
v_mfma_f32_16x16x32_bf16 v[32:35], v[64:67], v[200:203], v[32:35]
v_mfma_f32_16x16x32_bf16 v[24:27], v[68:71], v[204:207], v[24:27]
v_mfma_f32_16x16x32_bf16 v[28:31], v[68:71], v[208:211], v[28:31]
v_mfma_f32_16x16x32_bf16 v[32:35], v[68:71], v[212:215], v[32:35]
s_mul_i32 s54, s3, 12288
s_add_u32 s54, s54, 4096
v_lshl_add_u32 v60, v0, 4, s54
ds_read_b128 v[168:171], v60 offset:0
ds_read_b128 v[172:175], v60 offset:1024
ds_read_b128 v[176:179], v60 offset:2048
ds_read_b128 v[180:183], v60 offset:3072
ds_read_b128 v[184:187], v60 offset:4096
ds_read_b128 v[188:191], v60 offset:5120
ds_read_b128 v[192:195], v60 offset:6144
ds_read_b128 v[196:199], v60 offset:7168
ds_read_b128 v[200:203], v60 offset:8192
ds_read_b128 v[204:207], v60 offset:9216
ds_read_b128 v[208:211], v60 offset:10240
ds_read_b128 v[212:215], v60 offset:11264
s_waitcnt lgkmcnt(0)
v_mfma_f32_16x16x32_bf16 v[36:39], v[168:171], v[8:11], 0
v_mfma_f32_16x16x32_bf16 v[40:43], v[172:175], v[8:11], 0
v_mfma_f32_16x16x32_bf16 v[44:47], v[180:183], v[8:11], 0
v_mfma_f32_16x16x32_bf16 v[48:51], v[184:187], v[8:11], 0
v_mfma_f32_16x16x32_bf16 v[36:39], v[176:179], v[12:15], v[36:39]
v_mfma_f32_16x16x32_bf16 v[40:43], v[176:179], v[16:19], v[40:43]
v_mfma_f32_16x16x32_bf16 v[44:47], v[188:191], v[12:15], v[44:47]
v_mfma_f32_16x16x32_bf16 v[48:51], v[188:191], v[16:19], v[48:51]
s_nop 4
v_mov_b32_dpp v52, v36 quad_perm:[0,0,0,0] row_mask:0xf bank_mask:0xf
v_add_f32_dpp v52, v37, v52 quad_perm:[1,1,1,1] row_mask:0xf bank_mask:0xf
v_add_f32_dpp v52, v38, v52 quad_perm:[2,2,2,2] row_mask:0xf bank_mask:0xf
v_add_f32_dpp v52, v39, v52 quad_perm:[3,3,3,3] row_mask:0xf bank_mask:0xf
v_mov_b32_dpp v53, v40 quad_perm:[0,0,0,0] row_mask:0xf bank_mask:0xf
v_add_f32_dpp v53, v41, v53 quad_perm:[1,1,1,1] row_mask:0xf bank_mask:0xf
v_add_f32_dpp v53, v42, v53 quad_perm:[2,2,2,2] row_mask:0xf bank_mask:0xf
v_add_f32_dpp v53, v43, v53 quad_perm:[3,3,3,3] row_mask:0xf bank_mask:0xf
v_mov_b32_dpp v54, v44 quad_perm:[0,0,0,0] row_mask:0xf bank_mask:0xf
v_add_f32_dpp v54, v45, v54 quad_perm:[1,1,1,1] row_mask:0xf bank_mask:0xf
v_add_f32_dpp v54, v46, v54 quad_perm:[2,2,2,2] row_mask:0xf bank_mask:0xf
v_add_f32_dpp v54, v47, v54 quad_perm:[3,3,3,3] row_mask:0xf bank_mask:0xf
v_mov_b32_dpp v55, v48 quad_perm:[0,0,0,0] row_mask:0xf bank_mask:0xf
v_add_f32_dpp v55, v49, v55 quad_perm:[1,1,1,1] row_mask:0xf bank_mask:0xf
v_add_f32_dpp v55, v50, v55 quad_perm:[2,2,2,2] row_mask:0xf bank_mask:0xf
v_add_f32_dpp v55, v51, v55 quad_perm:[3,3,3,3] row_mask:0xf bank_mask:0xf
v_cvt_pk_bf16_f32 v62, v52, v53
v_cvt_pk_bf16_f32 v63, v54, v55
v_lshlrev_b32 v52, 16, v62
v_and_b32 v53, 0xffff0000, v62
v_lshlrev_b32 v54, 16, v63
v_and_b32 v55, 0xffff0000, v63
v_mul_f32 v52, s51, v52
v_mul_f32 v53, s51, v53
v_mul_f32 v54, s51, v54
v_mul_f32 v55, s51, v55
v_cvt_pk_bf16_f32 v62, v52, v53
v_cvt_pk_bf16_f32 v63, v54, v55
v_lshlrev_b32 v52, 16, v62
v_and_b32 v53, 0xffff0000, v62
v_lshlrev_b32 v54, 16, v63
v_and_b32 v55, 0xffff0000, v63
v_max3_f32 v59, v52, v53, v54
v_max_f32 v59, v59, v55
v_cmp_gt_f32 vcc, v59, v56
s_cbranch_vccnz L_rescale_12
L_back_13:
v_fma_f32 v52, v52, s50, v57
v_fma_f32 v53, v53, s50, v57
v_fma_f32 v54, v54, s50, v57
v_fma_f32 v55, v55, s50, v57
v_exp_f32 v52, v52
v_exp_f32 v53, v53
v_exp_f32 v54, v54
v_exp_f32 v55, v55
s_nop 0
v_cvt_pk_bf16_f32 v62, v52, v53
v_cvt_pk_bf16_f32 v63, v54, v55
v_add_f32 v60, v52, v53
v_add_f32 v61, v54, v55
v_perm_b32 v64, v62, v62, v20
v_perm_b32 v65, v62, v62, v21
v_perm_b32 v66, v62, v62, v22
v_perm_b32 v67, v62, v62, v23
v_perm_b32 v68, v63, v63, v20
v_perm_b32 v69, v63, v63, v21
v_perm_b32 v70, v63, v63, v22
v_perm_b32 v71, v63, v63, v23
v_add_f32 v60, v60, v61
v_add_f32 v58, v58, v60
s_nop 0
v_mfma_f32_16x16x32_bf16 v[24:27], v[64:67], v[192:195], v[24:27]
v_mfma_f32_16x16x32_bf16 v[28:31], v[64:67], v[196:199], v[28:31]
v_mfma_f32_16x16x32_bf16 v[32:35], v[64:67], v[200:203], v[32:35]
v_mfma_f32_16x16x32_bf16 v[24:27], v[68:71], v[204:207], v[24:27]
v_mfma_f32_16x16x32_bf16 v[28:31], v[68:71], v[208:211], v[28:31]
v_mfma_f32_16x16x32_bf16 v[32:35], v[68:71], v[212:215], v[32:35]
v_lshrrev_b32 v6, 5, v0
v_and_b32 v1, 7, v0
v_bfe_u32 v60, v0, 4, 1
v_mul_u32_u24 v204, 768, v6
v_lshl_add_u32 v204, v1, 5, v204
v_lshl_add_u32 v204, v60, 4, v204
s_mul_i32 s52, s3, 1536
s_add_u32 s52, s52, 4096
v_add_u32 v204, s52, v204
v_min_u32 v206, 47, v0
v_lshlrev_b32 v206, 4, v206
v_add_u32 v206, s52, v206
s_lshl_b32 s52, s3, 2
s_add_u32 s52, s52, 10304
v_mov_b32 v216, s52
s_lshl_b32 s52, s3, 4
s_add_u32 s52, s52, 10240
v_lshl_add_u32 v205, v7, 2, s52
v_lshlrev_b32 v207, 4, v0
s_and_b32 s53, s3, 1
s_mul_i32 s54, s53, 24
v_min_u32 v208, 23, v0
v_add_u32 v208, s54, v208
v_lshlrev_b32 v208, 4, v208
v_lshlrev_b32 v209, 10, v1
v_add_u32 v209, 768, v209
v_bfe_u32 v60, v0, 2, 2
v_lshl_add_u32 v61, v7, 3, v60
v_lshlrev_b32 v210, 8, v61
v_and_b32 v61, 1, v0
v_lshl_add_u32 v210, v61, 3, v210
v_add_u32 v210, 53248, v210
v_lshlrev_b32 v60, 1, v60
v_and_b32 v61, 1, v7
v_lshl_or_b32 v60, v61, 3, v60
v_bfe_u32 v61, v0, 1, 1
s_lshl_b32 s52, s3, 2
v_add_u32 v61, s52, v61
v_xor_b32 v215, v61, v60
v_xor_b32 v61, 2, v215
v_lshl_add_u32 v61, v61, 4, v210
v_lshl_add_u32 v210, v215, 4, v210
v_mov_b32 v215, v61
s_mul_i32 s52, s67, 384
s_mul_i32 s54, s53, 192
s_add_u32 s52, s52, s54
s_add_u32 s52, s52, 10368
v_min_u32 v211, 23, v0
v_lshl_add_u32 v211, v211, 3, s52
v_and_b32 v60, 1, v0
v_mul_u32_u24 v212, 384, v60
v_lshl_add_u32 v212, v7, 4, v212
v_add_u32 v212, 10368, v212
v_lshlrev_b32 v213, 9, v6
v_and_b32 v60, 31, v0
v_lshl_add_u32 v213, v60, 2, v213
s_lshl_b32 s52, s3, 7
v_add_u32 v213, s52, v213
s_lshl_b32 s52, s3, 10
s_add_u32 s52, s52, 11264
v_add_u32 v214, s52, v207
s_mov_b32 s40, 0xffff0000
s_mov_b32 s41, 0xffff0000
s_mov_b32 s42, 0
s_mov_b32 s43, -1
s_lshl_b32 s52, s48, 1
s_add_u32 s52, s52, s67
s_lshl_b32 s45, s52, 13
s_add_u32 s45, s45, 1048576
s_add_u32 s46, s45, 4096
s_lshl_b32 s52, s49, 10
s_add_u32 s44, s45, s52
s_lshl_b32 s52, s49, 5
s_add_u32 s53, s52, s48
s_lshl_b32 s47, s53, 10
s_add_u32 s47, s47, 2097152
s_lshl_b32 s53, s3, 3
s_add_u32 s52, s52, s53
s_lshl_b32 s68, s52, 10
s_add_u32 s68, s68, 2097152
s_add_u32 s69, s68, 4096
L_loop:
s_waitcnt vmcnt(6)
v_mfma_f32_16x16x32_bf16 v[36:39], v[72:75], v[8:11], 0
v_mfma_f32_16x16x32_bf16 v[40:43], v[76:79], v[8:11], 0
v_mfma_f32_16x16x32_bf16 v[44:47], v[84:87], v[8:11], 0
v_mfma_f32_16x16x32_bf16 v[48:51], v[88:91], v[8:11], 0
v_mfma_f32_16x16x32_bf16 v[36:39], v[80:83], v[12:15], v[36:39]
v_mfma_f32_16x16x32_bf16 v[40:43], v[80:83], v[16:19], v[40:43]
v_mfma_f32_16x16x32_bf16 v[44:47], v[92:95], v[12:15], v[44:47]
v_mfma_f32_16x16x32_bf16 v[48:51], v[92:95], v[16:19], v[48:51]
s_cmp_eq_u32 s57, 0
s_cbranch_scc1 L_new_14
s_add_u32 s56, s56, s71
s_sub_u32 s57, s57, 1
s_sub_u32 s71, s99, s71
s_branch L_have_15
L_new_14:
s_waitcnt lgkmcnt(0)
s_mov_b32 s71, 1
s_mov_b32 s99, 2
s_cmp_lt_u32 s60, 56
s_cselect_b32 s57, 1, 0
s_cmp_lt_u32 s60, 24
s_cselect_b32 s57, 3, s57
s_min_u32 s56, s60, 56
s_add_u32 s56, s56, s60
s_min_u32 s55, s60, 24
s_lshl_b32 s55, s55, 1
s_add_u32 s56, s56, s55
s_add_u32 s56, s56, 832
s_cmp_lt_u32 s56, 1024
s_cbranch_scc1 L_more_16
s_mov_b32 s59, 1
v_mov_b32 v60, 3584
ds_write_b32 v60, v60
s_branch L_nok_17
L_more_16:
L_have_15:
s_mul_i32 s58, s56, 6144
buffer_load_dwordx4 v[72:75], v2, s[28:31], s58 offen nt
buffer_load_dwordx4 v[76:79], v2, s[28:31], s58 offen offset:1536 nt
buffer_load_dwordx4 v[80:83], v4, s[28:31], s58 offen nt
buffer_load_dwordx4 v[84:87], v3, s[28:31], s58 offen nt
buffer_load_dwordx4 v[88:91], v3, s[28:31], s58 offen offset:1536 nt
buffer_load_dwordx4 v[92:95], v4, s[28:31], s58 offen offset:3072 nt
L_nok_17:
v_mov_b32_dpp v52, v36 quad_perm:[0,0,0,0] row_mask:0xf bank_mask:0xf
v_add_f32_dpp v52, v37, v52 quad_perm:[1,1,1,1] row_mask:0xf bank_mask:0xf
v_add_f32_dpp v52, v38, v52 quad_perm:[2,2,2,2] row_mask:0xf bank_mask:0xf
v_add_f32_dpp v52, v39, v52 quad_perm:[3,3,3,3] row_mask:0xf bank_mask:0xf
v_mov_b32_dpp v53, v40 quad_perm:[0,0,0,0] row_mask:0xf bank_mask:0xf
v_add_f32_dpp v53, v41, v53 quad_perm:[1,1,1,1] row_mask:0xf bank_mask:0xf
v_add_f32_dpp v53, v42, v53 quad_perm:[2,2,2,2] row_mask:0xf bank_mask:0xf
v_add_f32_dpp v53, v43, v53 quad_perm:[3,3,3,3] row_mask:0xf bank_mask:0xf
v_mov_b32_dpp v54, v44 quad_perm:[0,0,0,0] row_mask:0xf bank_mask:0xf
v_add_f32_dpp v54, v45, v54 quad_perm:[1,1,1,1] row_mask:0xf bank_mask:0xf
v_add_f32_dpp v54, v46, v54 quad_perm:[2,2,2,2] row_mask:0xf bank_mask:0xf
v_add_f32_dpp v54, v47, v54 quad_perm:[3,3,3,3] row_mask:0xf bank_mask:0xf
v_mov_b32_dpp v55, v48 quad_perm:[0,0,0,0] row_mask:0xf bank_mask:0xf
v_add_f32_dpp v55, v49, v55 quad_perm:[1,1,1,1] row_mask:0xf bank_mask:0xf
v_add_f32_dpp v55, v50, v55 quad_perm:[2,2,2,2] row_mask:0xf bank_mask:0xf
v_add_f32_dpp v55, v51, v55 quad_perm:[3,3,3,3] row_mask:0xf bank_mask:0xf
v_cvt_pk_bf16_f32 v62, v52, v53
v_cvt_pk_bf16_f32 v63, v54, v55
v_lshlrev_b32 v52, 16, v62
v_and_b32 v53, 0xffff0000, v62
v_lshlrev_b32 v54, 16, v63
v_and_b32 v55, 0xffff0000, v63
v_mul_f32 v52, s51, v52
v_mul_f32 v53, s51, v53
v_mul_f32 v54, s51, v54
v_mul_f32 v55, s51, v55
v_cvt_pk_bf16_f32 v62, v52, v53
v_cvt_pk_bf16_f32 v63, v54, v55
v_lshlrev_b32 v52, 16, v62
v_and_b32 v53, 0xffff0000, v62
v_lshlrev_b32 v54, 16, v63
v_and_b32 v55, 0xffff0000, v63
v_max3_f32 v59, v52, v53, v54
v_max_f32 v59, v59, v55
v_cmp_gt_f32 vcc, v59, v56
s_cbranch_vccnz L_rescale_18
L_back_19:
v_fma_f32 v52, v52, s50, v57
v_fma_f32 v53, v53, s50, v57
v_fma_f32 v54, v54, s50, v57
v_fma_f32 v55, v55, s50, v57
v_exp_f32 v52, v52
v_exp_f32 v53, v53
v_exp_f32 v54, v54
v_exp_f32 v55, v55
s_nop 0
v_cvt_pk_bf16_f32 v62, v52, v53
v_cvt_pk_bf16_f32 v63, v54, v55
v_add_f32 v60, v52, v53
v_add_f32 v61, v54, v55
v_perm_b32 v64, v62, v62, v20
v_perm_b32 v65, v62, v62, v21
v_perm_b32 v66, v62, v62, v22
v_perm_b32 v67, v62, v62, v23
v_perm_b32 v68, v63, v63, v20
v_perm_b32 v69, v63, v63, v21
v_perm_b32 v70, v63, v63, v22
v_perm_b32 v71, v63, v63, v23
v_add_f32 v60, v60, v61
v_add_f32 v58, v58, v60
s_cmp_eq_u32 s59, 0
s_cbranch_scc1 L_w6_20
s_waitcnt vmcnt(0)
L_w6_20:
s_waitcnt vmcnt(6)
v_mfma_f32_16x16x32_bf16 v[24:27], v[64:67], v[96:99], v[24:27]
v_mfma_f32_16x16x32_bf16 v[28:31], v[64:67], v[100:103], v[28:31]
v_mfma_f32_16x16x32_bf16 v[32:35], v[64:67], v[104:107], v[32:35]
v_mfma_f32_16x16x32_bf16 v[24:27], v[68:71], v[108:111], v[24:27]
v_mfma_f32_16x16x32_bf16 v[28:31], v[68:71], v[112:115], v[28:31]
v_mfma_f32_16x16x32_bf16 v[32:35], v[68:71], v[116:119], v[32:35]
s_cmp_eq_u32 s59, 0
s_cbranch_scc0 L_nov_21
buffer_load_dwordx4 v[96:99], v5, s[32:35], s58 offen offset:0 nt
buffer_load_dwordx4 v[100:103], v5, s[32:35], s58 offen offset:128 nt
buffer_load_dwordx4 v[104:107], v5, s[32:35], s58 offen offset:256 nt
buffer_load_dwordx4 v[108:111], v5, s[32:35], s58 offen offset:3072 nt
buffer_load_dwordx4 v[112:115], v5, s[32:35], s58 offen offset:3200 nt
buffer_load_dwordx4 v[116:119], v5, s[32:35], s58 offen offset:3328 nt
s_cmp_eq_u32 s57, 0
s_cbranch_scc0 L_nov_21
s_mov_b32 s60, 1
s_atomic_add s60, s[62:63], 0x0 glc
L_nov_21:
s_cmp_eq_u32 s59, 0
s_cbranch_scc1 L_loop
s_branch L_loopdone
L_rescale_1:
v_mov_b32 v60, v59
s_nop 1
v_permlane16_swap_b32 v60, v59
s_nop 1
v_max_f32 v59, v59, v60
v_mov_b32 v60, v59
s_nop 1
v_permlane32_swap_b32 v60, v59
s_nop 1
v_max_f32 v59, v59, v60
v_max_f32 v59, v59, v56
v_sub_f32 v60, v56, v59
v_mul_f32 v60, s50, v60
v_exp_f32 v60, v60
v_mov_b32 v56, v59
v_mul_f32 v57, s50, v59
v_sub_f32 v57, 0, v57
v_mul_f32 v24, v60, v24
v_mul_f32 v25, v60, v25
v_mul_f32 v26, v60, v26
v_mul_f32 v27, v60, v27
v_mul_f32 v28, v60, v28
v_mul_f32 v29, v60, v29
v_mul_f32 v30, v60, v30
v_mul_f32 v31, v60, v31
v_mul_f32 v32, v60, v32
v_mul_f32 v33, v60, v33
v_mul_f32 v34, v60, v34
v_mul_f32 v35, v60, v35
v_mul_f32 v58, v60, v58
s_branch L_back_2
L_rescale_7:
v_mov_b32 v60, v59
s_nop 1
v_permlane16_swap_b32 v60, v59
s_nop 1
v_max_f32 v59, v59, v60
v_mov_b32 v60, v59
s_nop 1
v_permlane32_swap_b32 v60, v59
s_nop 1
v_max_f32 v59, v59, v60
v_max_f32 v59, v59, v56
v_sub_f32 v60, v56, v59
v_mul_f32 v60, s50, v60
v_exp_f32 v60, v60
v_mov_b32 v56, v59
v_mul_f32 v57, s50, v59
v_sub_f32 v57, 0, v57
v_mul_f32 v24, v60, v24
v_mul_f32 v25, v60, v25
v_mul_f32 v26, v60, v26
v_mul_f32 v27, v60, v27
v_mul_f32 v28, v60, v28
v_mul_f32 v29, v60, v29
v_mul_f32 v30, v60, v30
v_mul_f32 v31, v60, v31
v_mul_f32 v32, v60, v32
v_mul_f32 v33, v60, v33
v_mul_f32 v34, v60, v34
v_mul_f32 v35, v60, v35
v_mul_f32 v58, v60, v58
s_branch L_back_8
L_rescale_10:
v_mov_b32 v60, v59
s_nop 1
v_permlane16_swap_b32 v60, v59
s_nop 1
v_max_f32 v59, v59, v60
v_mov_b32 v60, v59
s_nop 1
v_permlane32_swap_b32 v60, v59
s_nop 1
v_max_f32 v59, v59, v60
v_max_f32 v59, v59, v56
v_sub_f32 v60, v56, v59
v_mul_f32 v60, s50, v60
v_exp_f32 v60, v60
v_mov_b32 v56, v59
v_mul_f32 v57, s50, v59
v_sub_f32 v57, 0, v57
v_mul_f32 v24, v60, v24
v_mul_f32 v25, v60, v25
v_mul_f32 v26, v60, v26
v_mul_f32 v27, v60, v27
v_mul_f32 v28, v60, v28
v_mul_f32 v29, v60, v29
v_mul_f32 v30, v60, v30
v_mul_f32 v31, v60, v31
v_mul_f32 v32, v60, v32
v_mul_f32 v33, v60, v33
v_mul_f32 v34, v60, v34
v_mul_f32 v35, v60, v35
v_mul_f32 v58, v60, v58
s_branch L_back_11
L_rescale_12:
v_mov_b32 v60, v59
s_nop 1
v_permlane16_swap_b32 v60, v59
s_nop 1
v_max_f32 v59, v59, v60
v_mov_b32 v60, v59
s_nop 1
v_permlane32_swap_b32 v60, v59
s_nop 1
v_max_f32 v59, v59, v60
v_max_f32 v59, v59, v56
v_sub_f32 v60, v56, v59
v_mul_f32 v60, s50, v60
v_exp_f32 v60, v60
v_mov_b32 v56, v59
v_mul_f32 v57, s50, v59
v_sub_f32 v57, 0, v57
v_mul_f32 v24, v60, v24
v_mul_f32 v25, v60, v25
v_mul_f32 v26, v60, v26
v_mul_f32 v27, v60, v27
v_mul_f32 v28, v60, v28
v_mul_f32 v29, v60, v29
v_mul_f32 v30, v60, v30
v_mul_f32 v31, v60, v31
v_mul_f32 v32, v60, v32
v_mul_f32 v33, v60, v33
v_mul_f32 v34, v60, v34
v_mul_f32 v35, v60, v35
v_mul_f32 v58, v60, v58
s_branch L_back_13
L_rescale_18:
v_mov_b32 v60, v59
s_nop 1
v_permlane16_swap_b32 v60, v59
s_nop 1
v_max_f32 v59, v59, v60
v_mov_b32 v60, v59
s_nop 1
v_permlane32_swap_b32 v60, v59
s_nop 1
v_max_f32 v59, v59, v60
v_max_f32 v59, v59, v56
v_sub_f32 v60, v56, v59
v_mul_f32 v60, s50, v60
v_exp_f32 v60, v60
v_mov_b32 v56, v59
v_mul_f32 v57, s50, v59
v_sub_f32 v57, 0, v57
v_mul_f32 v24, v60, v24
v_mul_f32 v25, v60, v25
v_mul_f32 v26, v60, v26
v_mul_f32 v27, v60, v27
v_mul_f32 v28, v60, v28
v_mul_f32 v29, v60, v29
v_mul_f32 v30, v60, v30
v_mul_f32 v31, v60, v31
v_mul_f32 v32, v60, v32
v_mul_f32 v33, v60, v33
v_mul_f32 v34, v60, v34
v_mul_f32 v35, v60, v35
v_mul_f32 v58, v60, v58
s_branch L_back_19
L_loopdone:
s_mov_b32 exec_lo, 0x00ff00ff
s_mov_b32 exec_hi, 0xff00ff00
s_nop 1
ds_write_b128 v204, v[24:27] offset:0
ds_write_b128 v204, v[28:31] offset:256
ds_write_b128 v204, v[32:35] offset:512
s_mov_b32 exec_lo, 0x00010001
s_mov_b32 exec_hi, 0x00010001
ds_write_b32 v205, v58
s_lshl_b32 s52, s3, 2
s_add_u32 s52, s52, 10304
v_mov_b32 v60, s52
ds_write_b32 v60, v56
s_mov_b64 exec, -1
s_waitcnt lgkmcnt(0)
s_barrier
s_and_b32 s52, s3, 1
s_cmp_eq_u32 s52, 0
s_cbranch_scc0 L_nopub_22
ds_read_b128 v[168:171], v206 offset:0
ds_read_b128 v[172:175], v206 offset:768
ds_read_b128 v[176:179], v206 offset:1536
ds_read_b128 v[180:183], v206 offset:2304
s_lshl_b32 s52, s3, 4
s_add_u32 s52, s52, 10240
v_mov_b32 v60, s52
s_lshl_b32 s52, s3, 2
s_add_u32 s52, s52, 10304
v_mov_b32 v61, s52
ds_read_b128 v[184:187], v60
ds_read_b128 v[188:191], v60 offset:16
ds_read_b64 v[192:193], v61
v_cmp_eq_u32 vcc, 48, v0
s_waitcnt lgkmcnt(0)
v_max_f32 v194, v192, v193
v_sub_f32 v192, v192, v194
v_sub_f32 v193, v193, v194
v_mul_f32 v192, s50, v192
v_mul_f32 v193, s50, v193
v_exp_f32 v192, v192
v_exp_f32 v193, v193
v_add_f32 v168, v168, v172
v_add_f32 v169, v169, v173
v_add_f32 v170, v170, v174
v_add_f32 v171, v171, v175
v_add_f32 v176, v176, v180
v_add_f32 v177, v177, v181
v_add_f32 v178, v178, v182
v_add_f32 v179, v179, v183
v_add_f32 v184, v184, v185
v_add_f32 v186, v186, v187
v_add_f32 v188, v188, v189
v_add_f32 v190, v190, v191
v_add_f32 v184, v184, v186
v_add_f32 v188, v188, v190
v_mul_f32 v168, v192, v168
v_mul_f32 v169, v192, v169
v_mul_f32 v170, v192, v170
v_mul_f32 v171, v192, v171
v_mul_f32 v184, v192, v184
v_fma_f32 v168, v193, v176, v168
v_fma_f32 v169, v193, v177, v169
v_fma_f32 v170, v193, v178, v170
v_fma_f32 v171, v193, v179, v171
v_fma_f32 v184, v193, v188, v184
v_cndmask_b32 v168, v168, v194, vcc
v_cndmask_b32 v169, v169, v184, vcc
v_min_u32 v168, 0xfffffffe, v168
v_min_u32 v169, 0xfffffffe, v169
v_min_u32 v170, 0xfffffffe, v170
v_min_u32 v171, 0xfffffffe, v171
s_mov_b32 exec_hi, 0x00ffffff
buffer_store_dwordx4 v[168:171], v207, s[36:39], s44 offen sc1
s_mov_b32 exec_hi, -1
L_nopub_22:
s_cmp_ge_u32 s49, 5
s_cbranch_scc1 L_fin_stream
buffer_load_dwordx2 v[104:105], v209, s[36:39], s45 offen sc1
s_barrier
ds_read_b64_tr_b16 v[120:121], v210 offset:0
ds_read_b64_tr_b16 v[122:123], v210 offset:1024
ds_read_b64_tr_b16 v[124:125], v215 offset:0
ds_read_b64_tr_b16 v[126:127], v215 offset:1024
ds_read_b64_tr_b16 v[128:129], v210 offset:8192
ds_read_b64_tr_b16 v[130:131], v210 offset:9216
ds_read_b64_tr_b16 v[132:133], v215 offset:8192
ds_read_b64_tr_b16 v[134:135], v215 offset:9216
ds_read_b64_tr_b16 v[136:137], v210 offset:16384
ds_read_b64_tr_b16 v[138:139], v210 offset:17408
ds_read_b64_tr_b16 v[140:141], v215 offset:16384
ds_read_b64_tr_b16 v[142:143], v215 offset:17408
ds_read_b64_tr_b16 v[144:145], v210 offset:24576
ds_read_b64_tr_b16 v[146:147], v210 offset:25600
ds_read_b64_tr_b16 v[148:149], v215 offset:24576
ds_read_b64_tr_b16 v[150:151], v215 offset:25600
ds_read_b64_tr_b16 v[152:153], v210 offset:32768
ds_read_b64_tr_b16 v[154:155], v210 offset:33792
ds_read_b64_tr_b16 v[156:157], v215 offset:32768
ds_read_b64_tr_b16 v[158:159], v215 offset:33792
ds_read_b64_tr_b16 v[160:161], v210 offset:40960
ds_read_b64_tr_b16 v[162:163], v210 offset:41984
ds_read_b64_tr_b16 v[164:165], v215 offset:40960
ds_read_b64_tr_b16 v[166:167], v215 offset:41984
s_mov_b32 s66, 0
buffer_load_dwordx2 v[106:107], v209, s[36:39], s45 offen sc1
L_p2ml:
s_waitcnt vmcnt(1)
v_max_u32 v59, v104, v105
v_cmp_eq_u32 vcc, -1, v59
s_cbranch_vccz L_p2mlok
buffer_load_dwordx2 v[104:105], v209, s[36:39], s45 offen sc1
s_waitcnt vmcnt(1)
v_max_u32 v59, v106, v107
v_cmp_eq_u32 vcc, -1, v59
s_cbranch_vccz L_p2mlb
buffer_load_dwordx2 v[106:107], v209, s[36:39], s45 offen sc1
s_add_u32 s66, s66, 1
s_cmp_lt_u32 s66, 200000
s_cbranch_scc1 L_p2ml
s_waitcnt vmcnt(0)
s_branch L_p2mlok
L_p2mlb:
v_mov_b32 v108, v106
v_mov_b32 v109, v107
s_branch L_p2mlb2
L_p2mlok:
v_mov_b32 v108, v104
v_mov_b32 v109, v105
L_p2mlb2:
L_p2pay:
buffer_load_dwordx4 v[72:75], v208, s[36:39], s45 offen offset:0 sc1
buffer_load_dwordx4 v[76:79], v208, s[36:39], s45 offen offset:1024 sc1
buffer_load_dwordx4 v[80:83], v208, s[36:39], s45 offen offset:2048 sc1
buffer_load_dwordx4 v[84:87], v208, s[36:39], s45 offen offset:3072 sc1
buffer_load_dwordx4 v[88:91], v208, s[36:39], s46 offen offset:0 sc1
buffer_load_dwordx4 v[92:95], v208, s[36:39], s46 offen offset:1024 sc1
buffer_load_dwordx4 v[96:99], v208, s[36:39], s46 offen offset:2048 sc1
buffer_load_dwordx4 v[100:103], v208, s[36:39], s46 offen offset:3072 sc1
s_waitcnt vmcnt(0)
v_max3_u32 v59, v72, v73, v74
v_max3_u32 v59, v59, v75, v76
v_max3_u32 v59, v59, v77, v78
v_max3_u32 v59, v59, v79, v80
v_max3_u32 v59, v59, v81, v82
v_max3_u32 v59, v59, v83, v84
v_max3_u32 v59, v59, v85, v86
v_max3_u32 v59, v59, v87, v88
v_max3_u32 v59, v59, v89, v90
v_max3_u32 v59, v59, v91, v92
v_max3_u32 v59, v59, v93, v94
v_max3_u32 v59, v59, v95, v96
v_max3_u32 v59, v59, v97, v98
v_max3_u32 v59, v59, v99, v100
v_max3_u32 v59, v59, v101, v102
v_max_u32 v59, v59, v103
v_cmp_eq_u32 vcc, -1, v59
s_cbranch_vccz L_p2ok
s_add_u32 s66, s66, 1
s_cmp_lt_u32 s66, 200000
s_cbranch_scc1 L_p2pay
L_p2ok:
v_max_f32_dpp v56, v108, v108 quad_perm:[1,0,3,2] row_mask:0xf bank_mask:0xf
s_nop 1
v_max_f32_dpp v56, v56, v56 quad_perm:[2,3,0,1] row_mask:0xf bank_mask:0xf
s_nop 1
v_max_f32_dpp v56, v56, v56 row_half_mirror row_mask:0xf bank_mask:0xf
s_nop 1
v_sub_f32 v57, v108, v56
v_mul_f32 v57, s50, v57
v_exp_f32 v57, v57
s_nop 0
v_mul_f32 v58, v57, v109
s_nop 1
v_add_f32_dpp v58, v58, v58 quad_perm:[1,0,3,2] row_mask:0xf bank_mask:0xf
s_nop 1
v_add_f32_dpp v58, v58, v58 quad_perm:[2,3,0,1] row_mask:0xf bank_mask:0xf
s_nop 1
v_add_f32_dpp v58, v58, v58 row_half_mirror row_mask:0xf bank_mask:0xf
s_nop 1
v_rcp_f32 v58, v58
s_nop 0
v_mul_f32 v57, v57, v58
s_nop 1
v_mul_f32_dpp v52, v57, v72 row_newbcast:0 row_mask:0xf bank_mask:0xf
v_mul_f32_dpp v53, v57, v73 row_newbcast:0 row_mask:0xf bank_mask:0xf
v_mul_f32_dpp v54, v57, v74 row_newbcast:0 row_mask:0xf bank_mask:0xf
v_mul_f32_dpp v55, v57, v75 row_newbcast:0 row_mask:0xf bank_mask:0xf
v_fmac_f32_dpp v52, v57, v76 row_newbcast:1 row_mask:0xf bank_mask:0xf
v_fmac_f32_dpp v53, v57, v77 row_newbcast:1 row_mask:0xf bank_mask:0xf
v_fmac_f32_dpp v54, v57, v78 row_newbcast:1 row_mask:0xf bank_mask:0xf
v_fmac_f32_dpp v55, v57, v79 row_newbcast:1 row_mask:0xf bank_mask:0xf
v_fmac_f32_dpp v52, v57, v80 row_newbcast:2 row_mask:0xf bank_mask:0xf
v_fmac_f32_dpp v53, v57, v81 row_newbcast:2 row_mask:0xf bank_mask:0xf
v_fmac_f32_dpp v54, v57, v82 row_newbcast:2 row_mask:0xf bank_mask:0xf
v_fmac_f32_dpp v55, v57, v83 row_newbcast:2 row_mask:0xf bank_mask:0xf
v_fmac_f32_dpp v52, v57, v84 row_newbcast:3 row_mask:0xf bank_mask:0xf
v_fmac_f32_dpp v53, v57, v85 row_newbcast:3 row_mask:0xf bank_mask:0xf
v_fmac_f32_dpp v54, v57, v86 row_newbcast:3 row_mask:0xf bank_mask:0xf
v_fmac_f32_dpp v55, v57, v87 row_newbcast:3 row_mask:0xf bank_mask:0xf
v_fmac_f32_dpp v52, v57, v88 row_newbcast:4 row_mask:0xf bank_mask:0xf
v_fmac_f32_dpp v53, v57, v89 row_newbcast:4 row_mask:0xf bank_mask:0xf
v_fmac_f32_dpp v54, v57, v90 row_newbcast:4 row_mask:0xf bank_mask:0xf
v_fmac_f32_dpp v55, v57, v91 row_newbcast:4 row_mask:0xf bank_mask:0xf
v_fmac_f32_dpp v52, v57, v92 row_newbcast:5 row_mask:0xf bank_mask:0xf
v_fmac_f32_dpp v53, v57, v93 row_newbcast:5 row_mask:0xf bank_mask:0xf
v_fmac_f32_dpp v54, v57, v94 row_newbcast:5 row_mask:0xf bank_mask:0xf
v_fmac_f32_dpp v55, v57, v95 row_newbcast:5 row_mask:0xf bank_mask:0xf
v_fmac_f32_dpp v52, v57, v96 row_newbcast:6 row_mask:0xf bank_mask:0xf
v_fmac_f32_dpp v53, v57, v97 row_newbcast:6 row_mask:0xf bank_mask:0xf
v_fmac_f32_dpp v54, v57, v98 row_newbcast:6 row_mask:0xf bank_mask:0xf
v_fmac_f32_dpp v55, v57, v99 row_newbcast:6 row_mask:0xf bank_mask:0xf
v_fmac_f32_dpp v52, v57, v100 row_newbcast:7 row_mask:0xf bank_mask:0xf
v_fmac_f32_dpp v53, v57, v101 row_newbcast:7 row_mask:0xf bank_mask:0xf
v_fmac_f32_dpp v54, v57, v102 row_newbcast:7 row_mask:0xf bank_mask:0xf
v_fmac_f32_dpp v55, v57, v103 row_newbcast:7 row_mask:0xf bank_mask:0xf
v_cvt_pk_bf16_f32 v56, v52, v53
v_cvt_pk_bf16_f32 v57, v54, v55
ds_write_b64 v211, v[56:57]
s_waitcnt lgkmcnt(0)
s_barrier
ds_read_b128 v[8:11], v212 offset:0
ds_read_b128 v[12:15], v212 offset:64
ds_read_b128 v[16:19], v212 offset:128
ds_read_b128 v[24:27], v212 offset:192
ds_read_b128 v[28:31], v212 offset:256
ds_read_b128 v[32:35], v212 offset:320
s_waitcnt lgkmcnt(5)
v_mfma_f32_16x16x32_bf16 v[36:39], v[8:11], v[120:123], 0
v_mfma_f32_16x16x32_bf16 v[40:43], v[8:11], v[124:127], 0
s_waitcnt lgkmcnt(4)
v_mfma_f32_16x16x32_bf16 v[36:39], v[12:15], v[128:131], v[36:39]
v_mfma_f32_16x16x32_bf16 v[40:43], v[12:15], v[132:135], v[40:43]
s_waitcnt lgkmcnt(3)
v_mfma_f32_16x16x32_bf16 v[36:39], v[16:19], v[136:139], v[36:39]
v_mfma_f32_16x16x32_bf16 v[40:43], v[16:19], v[140:143], v[40:43]
s_waitcnt lgkmcnt(2)
v_mfma_f32_16x16x32_bf16 v[36:39], v[24:27], v[144:147], v[36:39]
v_mfma_f32_16x16x32_bf16 v[40:43], v[24:27], v[148:151], v[40:43]
s_waitcnt lgkmcnt(1)
v_mfma_f32_16x16x32_bf16 v[36:39], v[28:31], v[152:155], v[36:39]
v_mfma_f32_16x16x32_bf16 v[40:43], v[28:31], v[156:159], v[40:43]
s_waitcnt lgkmcnt(0)
v_mfma_f32_16x16x32_bf16 v[36:39], v[32:35], v[160:163], v[36:39]
v_mfma_f32_16x16x32_bf16 v[40:43], v[32:35], v[164:167], v[40:43]
s_nop 7
v_cndmask_b32 v52, v36, v40, s[40:41]
v_cndmask_b32 v53, v37, v41, s[40:41]
v_cndmask_b32 v52, v52, v53, s[42:43]
v_min_u32 v52, 0xfffffffe, v52
buffer_store_dword v52, v213, s[36:39], s47 offen sc1
s_cmp_eq_u32 s48, s49
s_cbranch_scc0 L_fin_stream
buffer_load_dwordx4 v[72:75], v207, s[36:39], s68 offen offset:0 sc1
buffer_load_dwordx4 v[76:79], v207, s[36:39], s68 offen offset:1024 sc1
buffer_load_dwordx4 v[80:83], v207, s[36:39], s68 offen offset:2048 sc1
buffer_load_dwordx4 v[84:87], v207, s[36:39], s68 offen offset:3072 sc1
buffer_load_dwordx4 v[88:91], v207, s[36:39], s69 offen offset:0 sc1
buffer_load_dwordx4 v[92:95], v207, s[36:39], s69 offen offset:1024 sc1
buffer_load_dwordx4 v[96:99], v207, s[36:39], s69 offen offset:2048 sc1
buffer_load_dwordx4 v[100:103], v207, s[36:39], s69 offen offset:3072 sc1
buffer_load_dwordx4 v[168:171], v207, s[36:39], s68 offen offset:0 sc1
buffer_load_dwordx4 v[172:175], v207, s[36:39], s68 offen offset:1024 sc1
buffer_load_dwordx4 v[176:179], v207, s[36:39], s68 offen offset:2048 sc1
buffer_load_dwordx4 v[180:183], v207, s[36:39], s68 offen offset:3072 sc1
buffer_load_dwordx4 v[184:187], v207, s[36:39], s69 offen offset:0 sc1
buffer_load_dwordx4 v[188:191], v207, s[36:39], s69 offen offset:1024 sc1
buffer_load_dwordx4 v[192:195], v207, s[36:39], s69 offen offset:2048 sc1
buffer_load_dwordx4 v[196:199], v207, s[36:39], s69 offen offset:3072 sc1
s_mov_b32 s66, 0
L_p3poll:
s_waitcnt vmcnt(8)
v_max3_u32 v59, v72, v73, v74
v_max3_u32 v59, v59, v75, v76
v_max3_u32 v59, v59, v77, v78
v_max3_u32 v59, v59, v79, v80
v_max3_u32 v59, v59, v81, v82
v_max3_u32 v59, v59, v83, v84
v_max3_u32 v59, v59, v85, v86
v_max3_u32 v59, v59, v87, v88
v_max3_u32 v59, v59, v89, v90
v_max3_u32 v59, v59, v91, v92
v_max3_u32 v59, v59, v93, v94
v_max3_u32 v59, v59, v95, v96
v_max3_u32 v59, v59, v97, v98
v_max3_u32 v59, v59, v99, v100
v_max3_u32 v59, v59, v101, v102
v_max_u32 v59, v59, v103
v_cmp_eq_u32 vcc, -1, v59
s_cbranch_vccz L_p3ok0
buffer_load_dwordx4 v[72:75], v207, s[36:39], s68 offen offset:0 sc1
buffer_load_dwordx4 v[76:79], v207, s[36:39], s68 offen offset:1024 sc1
buffer_load_dwordx4 v[80:83], v207, s[36:39], s68 offen offset:2048 sc1
buffer_load_dwordx4 v[84:87], v207, s[36:39], s68 offen offset:3072 sc1
buffer_load_dwordx4 v[88:91], v207, s[36:39], s69 offen offset:0 sc1
buffer_load_dwordx4 v[92:95], v207, s[36:39], s69 offen offset:1024 sc1
buffer_load_dwordx4 v[96:99], v207, s[36:39], s69 offen offset:2048 sc1
buffer_load_dwordx4 v[100:103], v207, s[36:39], s69 offen offset:3072 sc1
s_waitcnt vmcnt(8)
v_max3_u32 v59, v168, v169, v170
v_max3_u32 v59, v59, v171, v172
v_max3_u32 v59, v59, v173, v174
v_max3_u32 v59, v59, v175, v176
v_max3_u32 v59, v59, v177, v178
v_max3_u32 v59, v59, v179, v180
v_max3_u32 v59, v59, v181, v182
v_max3_u32 v59, v59, v183, v184
v_max3_u32 v59, v59, v185, v186
v_max3_u32 v59, v59, v187, v188
v_max3_u32 v59, v59, v189, v190
v_max3_u32 v59, v59, v191, v192
v_max3_u32 v59, v59, v193, v194
v_max3_u32 v59, v59, v195, v196
v_max3_u32 v59, v59, v197, v198
v_max_u32 v59, v59, v199
v_cmp_eq_u32 vcc, -1, v59
s_cbranch_vccz L_p3ok1
buffer_load_dwordx4 v[168:171], v207, s[36:39], s68 offen offset:0 sc1
buffer_load_dwordx4 v[172:175], v207, s[36:39], s68 offen offset:1024 sc1
buffer_load_dwordx4 v[176:179], v207, s[36:39], s68 offen offset:2048 sc1
buffer_load_dwordx4 v[180:183], v207, s[36:39], s68 offen offset:3072 sc1
buffer_load_dwordx4 v[184:187], v207, s[36:39], s69 offen offset:0 sc1
buffer_load_dwordx4 v[188:191], v207, s[36:39], s69 offen offset:1024 sc1
buffer_load_dwordx4 v[192:195], v207, s[36:39], s69 offen offset:2048 sc1
buffer_load_dwordx4 v[196:199], v207, s[36:39], s69 offen offset:3072 sc1
s_add_u32 s66, s66, 1
s_cmp_lt_u32 s66, 200000
s_cbranch_scc1 L_p3poll
L_p3ok1:
v_add_f32 v168, v168, v172
v_add_f32 v169, v169, v173
v_add_f32 v170, v170, v174
v_add_f32 v171, v171, v175
v_add_f32 v176, v176, v180
v_add_f32 v177, v177, v181
v_add_f32 v178, v178, v182
v_add_f32 v179, v179, v183
v_add_f32 v184, v184, v188
v_add_f32 v185, v185, v189
v_add_f32 v186, v186, v190
v_add_f32 v187, v187, v191
v_add_f32 v192, v192, v196
v_add_f32 v193, v193, v197
v_add_f32 v194, v194, v198
v_add_f32 v195, v195, v199
v_add_f32 v168, v168, v176
v_add_f32 v184, v184, v192
v_add_f32 v169, v169, v177
v_add_f32 v185, v185, v193
v_add_f32 v170, v170, v178
v_add_f32 v186, v186, v194
v_add_f32 v171, v171, v179
v_add_f32 v187, v187, v195
v_add_f32 v52, v168, v184
v_add_f32 v53, v169, v185
v_add_f32 v54, v170, v186
v_add_f32 v55, v171, v187
s_branch L_p3join
L_p3ok0:
v_add_f32 v72, v72, v76
v_add_f32 v73, v73, v77
v_add_f32 v74, v74, v78
v_add_f32 v75, v75, v79
v_add_f32 v80, v80, v84
v_add_f32 v81, v81, v85
v_add_f32 v82, v82, v86
v_add_f32 v83, v83, v87
v_add_f32 v88, v88, v92
v_add_f32 v89, v89, v93
v_add_f32 v90, v90, v94
v_add_f32 v91, v91, v95
v_add_f32 v96, v96, v100
v_add_f32 v97, v97, v101
v_add_f32 v98, v98, v102
v_add_f32 v99, v99, v103
v_add_f32 v72, v72, v80
v_add_f32 v88, v88, v96
v_add_f32 v73, v73, v81
v_add_f32 v89, v89, v97
v_add_f32 v74, v74, v82
v_add_f32 v90, v90, v98
v_add_f32 v75, v75, v83
v_add_f32 v91, v91, v99
v_add_f32 v52, v72, v88
v_add_f32 v53, v73, v89
v_add_f32 v54, v74, v90
v_add_f32 v55, v75, v91
L_p3join:
ds_write_b128 v214, v[52:55]
s_waitcnt lgkmcnt(0)
s_barrier
L_fin_stream:
s_endpgm
L_helper:
s_setprio 3
s_mov_b32 s36, s26
s_and_b32 s37, s27, 0xffff
s_mov_b32 s38, 4194304
s_mov_b32 s39, 0x20000
v_mov_b32 v16, 0
s_mov_b32 s52, 32768
buffer_load_dword v17, v16, s[36:39], s52 offen sc1
s_mov_b32 s40, s4
s_and_b32 s41, s5, 0xffff
s_mov_b32 s42, 2560
s_mov_b32 s43, 0x20000
s_mov_b32 s44, s10
s_and_b32 s45, s11, 0xffff
s_mov_b32 s46, 7864320
s_mov_b32 s47, 0x20000
v_lshlrev_b32 v2, 2, v0
buffer_load_dword v24, v2, s[40:43], 0 offen offset:0
buffer_load_dword v25, v2, s[40:43], 0 offen offset:256
buffer_load_dword v26, v2, s[40:43], 0 offen offset:512
buffer_load_dword v27, v2, s[40:43], 0 offen offset:768
buffer_load_dword v28, v2, s[40:43], 0 offen offset:1024
buffer_load_dword v29, v2, s[40:43], 0 offen offset:1280
buffer_load_dword v30, v2, s[40:43], 0 offen offset:1536
buffer_load_dword v31, v2, s[40:43], 0 offen offset:1792
buffer_load_dword v32, v2, s[40:43], 0 offen offset:2048
buffer_load_dword v33, v2, s[40:43], 0 offen offset:2304
v_mov_b32 v40, -1
v_mov_b32 v41, -1
v_mov_b32 v42, -1
v_mov_b32 v43, -1
v_lshlrev_b32 v11, 4, v0
s_lshl_b32 s52, s48, 4
s_add_u32 s52, s52, s49
s_lshl_b32 s52, s52, 10
s_add_u32 s52, s52, 1048576
buffer_store_dwordx4 v[40:43], v11, s[36:39], s52 offen sc1
s_add_u32 s52, s52, 8192
buffer_store_dwordx4 v[40:43], v11, s[36:39], s52 offen sc1
s_cmp_ge_u32 s49, 5
s_cbranch_scc1 L_noyclr_23
s_lshl_b32 s52, s49, 5
s_add_u32 s52, s52, s48
s_lshl_b32 s52, s52, 10
s_add_u32 s52, s52, 2097152
buffer_store_dwordx4 v[40:43], v11, s[36:39], s52 offen sc1
s_add_u32 s52, s52, 262144
buffer_store_dwordx4 v[40:43], v11, s[36:39], s52 offen sc1
L_noyclr_23:
s_cmp_eq_u32 s49, 0
s_cbranch_scc0 L_nocnt_24
s_mul_i32 s52, s48, 256
s_add_u32 s52, s52, 0
v_mul_u32_u24 v12, 8192, v0
v_mov_b32 v13, 0
s_mov_b64 exec, 3
buffer_store_dword v13, v12, s[36:39], s52 offen sc1
s_mov_b64 exec, -1
L_nocnt_24:
v_lshrrev_b32 v7, 4, v0
v_and_b32 v6, 15, v0
v_mul_u32_u24 v8, 12288, v7
v_lshl_add_u32 v8, v6, 4, v8
v_lshrrev_b32 v9, 3, v6
v_lshl_add_u32 v9, v9, 2, v7
v_mul_u32_u24 v9, 12288, v9
v_and_b32 v10, 7, v6
v_lshl_add_u32 v9, v10, 4, v9
v_add_u32 v9, 256, v9
s_mul_i32 s52, s49, 983040
s_mul_i32 s53, s48, 384
s_add_u32 s52, s52, s53
buffer_load_dwordx4 v[96:99], v8, s[44:47], s52 offen nt
buffer_load_dwordx4 v[104:107], v9, s[44:47], s52 offen nt
s_add_u32 s53, s52, 49152
buffer_load_dwordx4 v[100:103], v8, s[44:47], s53 offen nt
s_add_u32 s52, s52, 98304
buffer_load_dwordx4 v[108:111], v8, s[44:47], s52 offen nt
buffer_load_dwordx4 v[116:119], v9, s[44:47], s52 offen nt
s_add_u32 s53, s52, 49152
buffer_load_dwordx4 v[112:115], v8, s[44:47], s53 offen nt
s_add_u32 s52, s52, 98304
buffer_load_dwordx4 v[120:123], v8, s[44:47], s52 offen nt
buffer_load_dwordx4 v[128:131], v9, s[44:47], s52 offen nt
s_add_u32 s53, s52, 49152
buffer_load_dwordx4 v[124:127], v8, s[44:47], s53 offen nt
s_add_u32 s52, s52, 98304
buffer_load_dwordx4 v[132:135], v8, s[44:47], s52 offen nt
buffer_load_dwordx4 v[140:143], v9, s[44:47], s52 offen nt
s_add_u32 s53, s52, 49152
buffer_load_dwordx4 v[136:139], v8, s[44:47], s53 offen nt
s_add_u32 s52, s52, 98304
buffer_load_dwordx4 v[144:147], v8, s[44:47], s52 offen nt
buffer_load_dwordx4 v[152:155], v9, s[44:47], s52 offen nt
s_add_u32 s53, s52, 49152
buffer_load_dwordx4 v[148:151], v8, s[44:47], s53 offen nt
s_add_u32 s52, s52, 98304
buffer_load_dwordx4 v[156:159], v8, s[44:47], s52 offen nt
buffer_load_dwordx4 v[164:167], v9, s[44:47], s52 offen nt
s_add_u32 s53, s52, 49152
buffer_load_dwordx4 v[160:163], v8, s[44:47], s53 offen nt
s_add_u32 s52, s52, 98304
buffer_load_dwordx4 v[168:171], v8, s[44:47], s52 offen nt
buffer_load_dwordx4 v[176:179], v9, s[44:47], s52 offen nt
s_add_u32 s53, s52, 49152
buffer_load_dwordx4 v[172:175], v8, s[44:47], s53 offen nt
s_add_u32 s52, s52, 98304
buffer_load_dwordx4 v[180:183], v8, s[44:47], s52 offen nt
buffer_load_dwordx4 v[188:191], v9, s[44:47], s52 offen nt
s_add_u32 s53, s52, 49152
buffer_load_dwordx4 v[184:187], v8, s[44:47], s53 offen nt
s_add_u32 s52, s52, 98304
buffer_load_dwordx4 v[192:195], v8, s[44:47], s52 offen nt
buffer_load_dwordx4 v[200:203], v9, s[44:47], s52 offen nt
s_add_u32 s53, s52, 49152
buffer_load_dwordx4 v[196:199], v8, s[44:47], s53 offen nt
s_add_u32 s52, s52, 98304
buffer_load_dwordx4 v[204:207], v8, s[44:47], s52 offen nt
buffer_load_dwordx4 v[212:215], v9, s[44:47], s52 offen nt
s_add_u32 s53, s52, 49152
buffer_load_dwordx4 v[208:211], v8, s[44:47], s53 offen nt
s_waitcnt vmcnt(30)
v_mov_b32 v5, 0xff
v_and_b32 v18, 0xff, v17
v_cmp_eq_u32 vcc, v18, v5
s_mov_b32 s52, 1664525
v_mul_lo_u32 v17, v17, s52
v_cndmask_b32 v18, v18, v16, vcc
v_add_u32 v17, 1013904223, v17
v_add_u32 v18, 1, v18
v_bfi_b32 v17, v5, v18, v17
v_lshlrev_b32 v44, 16, v24
v_and_b32 v45, 0xffff0000, v24
v_lshlrev_b32 v46, 16, v25
v_and_b32 v47, 0xffff0000, v25
v_lshlrev_b32 v48, 16, v26
v_and_b32 v49, 0xffff0000, v26
v_lshlrev_b32 v50, 16, v27
v_and_b32 v51, 0xffff0000, v27
v_lshlrev_b32 v52, 16, v28
v_and_b32 v53, 0xffff0000, v28
v_lshlrev_b32 v54, 16, v29
v_and_b32 v55, 0xffff0000, v29
v_lshlrev_b32 v56, 16, v30
v_and_b32 v57, 0xffff0000, v30
v_lshlrev_b32 v58, 16, v31
v_and_b32 v59, 0xffff0000, v31
v_lshlrev_b32 v60, 16, v32
v_and_b32 v61, 0xffff0000, v32
v_lshlrev_b32 v62, 16, v33
v_and_b32 v63, 0xffff0000, v33
v_add_f32 v64, v44, v45
v_add_f32 v64, v64, v46
v_add_f32 v64, v64, v47
v_add_f32 v64, v64, v48
v_add_f32 v64, v64, v49
v_add_f32 v64, v64, v50
v_add_f32 v64, v64, v51
v_add_f32 v64, v64, v52
v_add_f32 v64, v64, v53
v_add_f32 v65, v54, v55
v_add_f32 v65, v65, v56
v_add_f32 v65, v65, v57
v_add_f32 v65, v65, v58
v_add_f32 v65, v65, v59
v_add_f32 v65, v65, v60
v_add_f32 v65, v65, v61
v_add_f32 v65, v65, v62
v_add_f32 v65, v65, v63
s_nop 1
v_add_f32_dpp v64, v64, v64 quad_perm:[1,0,3,2] row_mask:0xf bank_mask:0xf
v_add_f32_dpp v65, v65, v65 quad_perm:[1,0,3,2] row_mask:0xf bank_mask:0xf
s_nop 1
v_add_f32_dpp v64, v64, v64 quad_perm:[2,3,0,1] row_mask:0xf bank_mask:0xf
v_add_f32_dpp v65, v65, v65 quad_perm:[2,3,0,1] row_mask:0xf bank_mask:0xf
s_nop 1
v_add_f32_dpp v64, v64, v64 row_half_mirror row_mask:0xf bank_mask:0xf
v_add_f32_dpp v65, v65, v65 row_half_mirror row_mask:0xf bank_mask:0xf
s_nop 1
v_add_f32_dpp v64, v64, v64 row_mirror row_mask:0xf bank_mask:0xf
v_add_f32_dpp v65, v65, v65 row_mirror row_mask:0xf bank_mask:0xf
s_nop 1
v_mov_b32 v66, v64
v_mov_b32 v67, v65
s_nop 1
v_permlane16_swap_b32 v66, v64
v_permlane16_swap_b32 v67, v65
s_nop 1
v_add_f32 v64, v64, v66
v_add_f32 v65, v65, v67
v_mov_b32 v66, v64
v_mov_b32 v67, v65
s_nop 1
v_permlane32_swap_b32 v66, v64
v_permlane32_swap_b32 v67, v65
s_nop 1
v_add_f32 v64, v64, v66
v_add_f32 v65, v65, v67
v_mul_f32 v64, 0x3acccccd, v64
v_mul_f32 v65, 0x3acccccd, v65
v_sub_f32 v66, v44, v64
v_mul_f32 v68, v66, v66
v_sub_f32 v66, v45, v64
v_fma_f32 v68, v66, v66, v68
v_sub_f32 v66, v46, v64
v_fma_f32 v68, v66, v66, v68
v_sub_f32 v66, v47, v64
v_fma_f32 v68, v66, v66, v68
v_sub_f32 v66, v48, v64
v_fma_f32 v68, v66, v66, v68
v_sub_f32 v66, v49, v64
v_fma_f32 v68, v66, v66, v68
v_sub_f32 v66, v50, v64
v_fma_f32 v68, v66, v66, v68
v_sub_f32 v66, v51, v64
v_fma_f32 v68, v66, v66, v68
v_sub_f32 v66, v52, v64
v_fma_f32 v68, v66, v66, v68
v_sub_f32 v66, v53, v64
v_fma_f32 v68, v66, v66, v68
v_sub_f32 v66, v54, v65
v_mul_f32 v69, v66, v66
v_sub_f32 v66, v55, v65
v_fma_f32 v69, v66, v66, v69
v_sub_f32 v66, v56, v65
v_fma_f32 v69, v66, v66, v69
v_sub_f32 v66, v57, v65
v_fma_f32 v69, v66, v66, v69
v_sub_f32 v66, v58, v65
v_fma_f32 v69, v66, v66, v69
v_sub_f32 v66, v59, v65
v_fma_f32 v69, v66, v66, v69
v_sub_f32 v66, v60, v65
v_fma_f32 v69, v66, v66, v69
v_sub_f32 v66, v61, v65
v_fma_f32 v69, v66, v66, v69
v_sub_f32 v66, v62, v65
v_fma_f32 v69, v66, v66, v69
v_sub_f32 v66, v63, v65
v_fma_f32 v69, v66, v66, v69
s_nop 1
v_add_f32_dpp v68, v68, v68 quad_perm:[1,0,3,2] row_mask:0xf bank_mask:0xf
v_add_f32_dpp v69, v69, v69 quad_perm:[1,0,3,2] row_mask:0xf bank_mask:0xf
s_nop 1
v_add_f32_dpp v68, v68, v68 quad_perm:[2,3,0,1] row_mask:0xf bank_mask:0xf
v_add_f32_dpp v69, v69, v69 quad_perm:[2,3,0,1] row_mask:0xf bank_mask:0xf
s_nop 1
v_add_f32_dpp v68, v68, v68 row_half_mirror row_mask:0xf bank_mask:0xf
v_add_f32_dpp v69, v69, v69 row_half_mirror row_mask:0xf bank_mask:0xf
s_nop 1
v_add_f32_dpp v68, v68, v68 row_mirror row_mask:0xf bank_mask:0xf
v_add_f32_dpp v69, v69, v69 row_mirror row_mask:0xf bank_mask:0xf
s_nop 1
v_mov_b32 v66, v68
v_mov_b32 v67, v69
s_nop 1
v_permlane16_swap_b32 v66, v68
v_permlane16_swap_b32 v67, v69
s_nop 1
v_add_f32 v68, v68, v66
v_add_f32 v69, v69, v67
v_mov_b32 v66, v68
v_mov_b32 v67, v69
s_nop 1
v_permlane32_swap_b32 v66, v68
v_permlane32_swap_b32 v67, v69
s_nop 1
v_add_f32 v68, v68, v66
v_add_f32 v69, v69, v67
v_mul_f32 v68, 0x3acccccd, v68
v_mul_f32 v69, 0x3acccccd, v69
v_cvt_pk_bf16_f32 v19, v64, v65
v_lshlrev_b32 v64, 16, v19
v_and_b32 v65, 0xffff0000, v19
v_cvt_pk_bf16_f32 v19, v68, v69
v_lshlrev_b32 v68, 16, v19
v_and_b32 v69, 0xffff0000, v19
v_add_f32 v68, 0x3727c5ac, v68
v_add_f32 v69, 0x3727c5ac, v69
v_cvt_pk_bf16_f32 v19, v68, v69
v_lshlrev_b32 v68, 16, v19
v_and_b32 v69, 0xffff0000, v19
v_sqrt_f32 v68, v68
v_sqrt_f32 v69, v69
s_nop 0
v_cvt_pk_bf16_f32 v19, v68, v69
v_lshlrev_b32 v68, 16, v19
v_and_b32 v69, 0xffff0000, v19
v_rcp_f32 v68, v68
v_rcp_f32 v69, v69
v_sub_f32 v44, v44, v64
v_sub_f32 v54, v54, v65
v_cvt_pk_bf16_f32 v19, v44, v54
v_lshlrev_b32 v44, 16, v19
v_and_b32 v54, 0xffff0000, v19
v_sub_f32 v45, v45, v64
v_sub_f32 v55, v55, v65
v_cvt_pk_bf16_f32 v19, v45, v55
v_lshlrev_b32 v45, 16, v19
v_and_b32 v55, 0xffff0000, v19
v_sub_f32 v46, v46, v64
v_sub_f32 v56, v56, v65
v_cvt_pk_bf16_f32 v19, v46, v56
v_lshlrev_b32 v46, 16, v19
v_and_b32 v56, 0xffff0000, v19
v_sub_f32 v47, v47, v64
v_sub_f32 v57, v57, v65
v_cvt_pk_bf16_f32 v19, v47, v57
v_lshlrev_b32 v47, 16, v19
v_and_b32 v57, 0xffff0000, v19
v_sub_f32 v48, v48, v64
v_sub_f32 v58, v58, v65
v_cvt_pk_bf16_f32 v19, v48, v58
v_lshlrev_b32 v48, 16, v19
v_and_b32 v58, 0xffff0000, v19
v_sub_f32 v49, v49, v64
v_sub_f32 v59, v59, v65
v_cvt_pk_bf16_f32 v19, v49, v59
v_lshlrev_b32 v49, 16, v19
v_and_b32 v59, 0xffff0000, v19
v_sub_f32 v50, v50, v64
v_sub_f32 v60, v60, v65
v_cvt_pk_bf16_f32 v19, v50, v60
v_lshlrev_b32 v50, 16, v19
v_and_b32 v60, 0xffff0000, v19
v_sub_f32 v51, v51, v64
v_sub_f32 v61, v61, v65
v_cvt_pk_bf16_f32 v19, v51, v61
v_lshlrev_b32 v51, 16, v19
v_and_b32 v61, 0xffff0000, v19
v_sub_f32 v52, v52, v64
v_sub_f32 v62, v62, v65
v_cvt_pk_bf16_f32 v19, v52, v62
v_lshlrev_b32 v52, 16, v19
v_and_b32 v62, 0xffff0000, v19
v_sub_f32 v53, v53, v64
v_sub_f32 v63, v63, v65
v_cvt_pk_bf16_f32 v19, v53, v63
v_lshlrev_b32 v53, 16, v19
v_and_b32 v63, 0xffff0000, v19
v_mul_f32 v44, v44, v68
v_mul_f32 v54, v54, v69
v_mul_f32 v45, v45, v68
v_mul_f32 v55, v55, v69
v_mul_f32 v46, v46, v68
v_mul_f32 v56, v56, v69
v_mul_f32 v47, v47, v68
v_mul_f32 v57, v57, v69
v_mul_f32 v48, v48, v68
v_mul_f32 v58, v58, v69
v_mul_f32 v49, v49, v68
v_mul_f32 v59, v59, v69
v_mul_f32 v50, v50, v68
v_mul_f32 v60, v60, v69
v_mul_f32 v51, v51, v68
v_mul_f32 v61, v61, v69
v_mul_f32 v52, v52, v68
v_mul_f32 v62, v62, v69
v_mul_f32 v53, v53, v68
v_mul_f32 v63, v63, v69
v_lshlrev_b32 v2, 3, v0
v_cvt_pk_bf16_f32 v70, v44, v54
v_cvt_pk_bf16_f32 v71, v45, v55
v_cvt_pk_bf16_f32 v72, v46, v56
v_cvt_pk_bf16_f32 v73, v47, v57
v_cvt_pk_bf16_f32 v74, v48, v58
v_cvt_pk_bf16_f32 v75, v49, v59
v_cvt_pk_bf16_f32 v76, v50, v60
v_cvt_pk_bf16_f32 v77, v51, v61
v_cvt_pk_bf16_f32 v78, v52, v62
v_cvt_pk_bf16_f32 v79, v53, v63
ds_write_b64 v2, v[70:71] offset:0
ds_write_b64 v2, v[72:73] offset:512
ds_write_b64 v2, v[74:75] offset:1024
ds_write_b64 v2, v[76:77] offset:1536
ds_write_b64 v2, v[78:79] offset:2048
s_mul_i32 s52, s49, 320
v_lshl_add_u32 v3, v7, 2, s52
s_waitcnt lgkmcnt(0)
ds_read_b32 v44, v3 offset:0
ds_read_b32 v45, v3 offset:16
ds_read_b32 v46, v3 offset:32
ds_read_b32 v47, v3 offset:48
ds_read_b32 v48, v3 offset:64
ds_read_b32 v49, v3 offset:80
ds_read_b32 v50, v3 offset:96
ds_read_b32 v51, v3 offset:112
ds_read_b32 v52, v3 offset:128
ds_read_b32 v53, v3 offset:144
ds_read_b32 v54, v3 offset:160
ds_read_b32 v55, v3 offset:176
ds_read_b32 v56, v3 offset:192
ds_read_b32 v57, v3 offset:208
ds_read_b32 v58, v3 offset:224
ds_read_b32 v59, v3 offset:240
ds_read_b32 v60, v3 offset:256
ds_read_b32 v61, v3 offset:272
ds_read_b32 v62, v3 offset:288
ds_read_b32 v63, v3 offset:304
s_waitcnt lgkmcnt(0)
s_waitcnt vmcnt(0)
v_perm_b32 v76, v44, v44, v20
v_perm_b32 v77, v44, v44, v21
v_perm_b32 v78, v44, v44, v22
v_perm_b32 v79, v44, v44, v23
v_perm_b32 v80, v45, v45, v20
v_perm_b32 v81, v45, v45, v21
v_perm_b32 v82, v45, v45, v22
v_perm_b32 v83, v45, v45, v23
s_nop 1
v_mfma_f32_16x16x32_bf16 v[64:67], v[76:79], v[96:99], 0
v_mfma_f32_16x16x32_bf16 v[68:71], v[76:79], v[104:107], 0
v_mfma_f32_16x16x32_bf16 v[64:67], v[80:83], v[100:103], v[64:67]
v_mfma_f32_16x16x32_bf16 v[72:75], v[80:83], v[104:107], 0
v_perm_b32 v76, v46, v46, v20
v_perm_b32 v77, v46, v46, v21
v_perm_b32 v78, v46, v46, v22
v_perm_b32 v79, v46, v46, v23
v_perm_b32 v80, v47, v47, v20
v_perm_b32 v81, v47, v47, v21
v_perm_b32 v82, v47, v47, v22
v_perm_b32 v83, v47, v47, v23
s_nop 1
v_mfma_f32_16x16x32_bf16 v[64:67], v[76:79], v[108:111], v[64:67]
v_mfma_f32_16x16x32_bf16 v[68:71], v[76:79], v[116:119], v[68:71]
v_mfma_f32_16x16x32_bf16 v[64:67], v[80:83], v[112:115], v[64:67]
v_mfma_f32_16x16x32_bf16 v[72:75], v[80:83], v[116:119], v[72:75]
v_perm_b32 v76, v48, v48, v20
v_perm_b32 v77, v48, v48, v21
v_perm_b32 v78, v48, v48, v22
v_perm_b32 v79, v48, v48, v23
v_perm_b32 v80, v49, v49, v20
v_perm_b32 v81, v49, v49, v21
v_perm_b32 v82, v49, v49, v22
v_perm_b32 v83, v49, v49, v23
s_nop 1
v_mfma_f32_16x16x32_bf16 v[64:67], v[76:79], v[120:123], v[64:67]
v_mfma_f32_16x16x32_bf16 v[68:71], v[76:79], v[128:131], v[68:71]
v_mfma_f32_16x16x32_bf16 v[64:67], v[80:83], v[124:127], v[64:67]
v_mfma_f32_16x16x32_bf16 v[72:75], v[80:83], v[128:131], v[72:75]
v_perm_b32 v76, v50, v50, v20
v_perm_b32 v77, v50, v50, v21
v_perm_b32 v78, v50, v50, v22
v_perm_b32 v79, v50, v50, v23
v_perm_b32 v80, v51, v51, v20
v_perm_b32 v81, v51, v51, v21
v_perm_b32 v82, v51, v51, v22
v_perm_b32 v83, v51, v51, v23
s_nop 1
v_mfma_f32_16x16x32_bf16 v[64:67], v[76:79], v[132:135], v[64:67]
v_mfma_f32_16x16x32_bf16 v[68:71], v[76:79], v[140:143], v[68:71]
v_mfma_f32_16x16x32_bf16 v[64:67], v[80:83], v[136:139], v[64:67]
v_mfma_f32_16x16x32_bf16 v[72:75], v[80:83], v[140:143], v[72:75]
v_perm_b32 v76, v52, v52, v20
v_perm_b32 v77, v52, v52, v21
v_perm_b32 v78, v52, v52, v22
v_perm_b32 v79, v52, v52, v23
v_perm_b32 v80, v53, v53, v20
v_perm_b32 v81, v53, v53, v21
v_perm_b32 v82, v53, v53, v22
v_perm_b32 v83, v53, v53, v23
s_nop 1
v_mfma_f32_16x16x32_bf16 v[64:67], v[76:79], v[144:147], v[64:67]
v_mfma_f32_16x16x32_bf16 v[68:71], v[76:79], v[152:155], v[68:71]
v_mfma_f32_16x16x32_bf16 v[64:67], v[80:83], v[148:151], v[64:67]
v_mfma_f32_16x16x32_bf16 v[72:75], v[80:83], v[152:155], v[72:75]
v_perm_b32 v76, v54, v54, v20
v_perm_b32 v77, v54, v54, v21
v_perm_b32 v78, v54, v54, v22
v_perm_b32 v79, v54, v54, v23
v_perm_b32 v80, v55, v55, v20
v_perm_b32 v81, v55, v55, v21
v_perm_b32 v82, v55, v55, v22
v_perm_b32 v83, v55, v55, v23
s_nop 1
v_mfma_f32_16x16x32_bf16 v[64:67], v[76:79], v[156:159], v[64:67]
v_mfma_f32_16x16x32_bf16 v[68:71], v[76:79], v[164:167], v[68:71]
v_mfma_f32_16x16x32_bf16 v[64:67], v[80:83], v[160:163], v[64:67]
v_mfma_f32_16x16x32_bf16 v[72:75], v[80:83], v[164:167], v[72:75]
v_perm_b32 v76, v56, v56, v20
v_perm_b32 v77, v56, v56, v21
v_perm_b32 v78, v56, v56, v22
v_perm_b32 v79, v56, v56, v23
v_perm_b32 v80, v57, v57, v20
v_perm_b32 v81, v57, v57, v21
v_perm_b32 v82, v57, v57, v22
v_perm_b32 v83, v57, v57, v23
s_nop 1
v_mfma_f32_16x16x32_bf16 v[64:67], v[76:79], v[168:171], v[64:67]
v_mfma_f32_16x16x32_bf16 v[68:71], v[76:79], v[176:179], v[68:71]
v_mfma_f32_16x16x32_bf16 v[64:67], v[80:83], v[172:175], v[64:67]
v_mfma_f32_16x16x32_bf16 v[72:75], v[80:83], v[176:179], v[72:75]
v_perm_b32 v76, v58, v58, v20
v_perm_b32 v77, v58, v58, v21
v_perm_b32 v78, v58, v58, v22
v_perm_b32 v79, v58, v58, v23
v_perm_b32 v80, v59, v59, v20
v_perm_b32 v81, v59, v59, v21
v_perm_b32 v82, v59, v59, v22
v_perm_b32 v83, v59, v59, v23
s_nop 1
v_mfma_f32_16x16x32_bf16 v[64:67], v[76:79], v[180:183], v[64:67]
v_mfma_f32_16x16x32_bf16 v[68:71], v[76:79], v[188:191], v[68:71]
v_mfma_f32_16x16x32_bf16 v[64:67], v[80:83], v[184:187], v[64:67]
v_mfma_f32_16x16x32_bf16 v[72:75], v[80:83], v[188:191], v[72:75]
v_perm_b32 v76, v60, v60, v20
v_perm_b32 v77, v60, v60, v21
v_perm_b32 v78, v60, v60, v22
v_perm_b32 v79, v60, v60, v23
v_perm_b32 v80, v61, v61, v20
v_perm_b32 v81, v61, v61, v21
v_perm_b32 v82, v61, v61, v22
v_perm_b32 v83, v61, v61, v23
s_nop 1
v_mfma_f32_16x16x32_bf16 v[64:67], v[76:79], v[192:195], v[64:67]
v_mfma_f32_16x16x32_bf16 v[68:71], v[76:79], v[200:203], v[68:71]
v_mfma_f32_16x16x32_bf16 v[64:67], v[80:83], v[196:199], v[64:67]
v_mfma_f32_16x16x32_bf16 v[72:75], v[80:83], v[200:203], v[72:75]
v_perm_b32 v76, v62, v62, v20
v_perm_b32 v77, v62, v62, v21
v_perm_b32 v78, v62, v62, v22
v_perm_b32 v79, v62, v62, v23
v_perm_b32 v80, v63, v63, v20
v_perm_b32 v81, v63, v63, v21
v_perm_b32 v82, v63, v63, v22
v_perm_b32 v83, v63, v63, v23
s_nop 1
v_mfma_f32_16x16x32_bf16 v[64:67], v[76:79], v[204:207], v[64:67]
v_mfma_f32_16x16x32_bf16 v[68:71], v[76:79], v[212:215], v[68:71]
v_mfma_f32_16x16x32_bf16 v[64:67], v[80:83], v[208:211], v[64:67]
v_mfma_f32_16x16x32_bf16 v[72:75], v[80:83], v[212:215], v[72:75]
s_nop 7
v_add_f32_dpp v68, v72, v68 row_ror:8 row_mask:0xf bank_mask:0xf
v_add_f32_dpp v69, v73, v69 row_ror:8 row_mask:0xf bank_mask:0xf
v_add_f32_dpp v70, v74, v70 row_ror:8 row_mask:0xf bank_mask:0xf
v_add_f32_dpp v71, v75, v71 row_ror:8 row_mask:0xf bank_mask:0xf
v_bfi_b32 v64, v5, v18, v64
v_bfi_b32 v65, v5, v18, v65
v_bfi_b32 v66, v5, v18, v66
v_bfi_b32 v67, v5, v18, v67
v_bfi_b32 v68, v5, v18, v68
v_bfi_b32 v69, v5, v18, v69
v_bfi_b32 v70, v5, v18, v70
v_bfi_b32 v71, v5, v18, v71
v_lshrrev_b32 v10, 5, v0
v_mul_u32_u24 v10, 768, v10
v_lshl_add_u32 v10, v6, 5, v10
v_and_b32 v11, 1, v7
v_lshl_add_u32 v10, v11, 4, v10
s_lshl_b32 s52, s2, 11
s_add_u32 s52, s52, 65536
buffer_store_dwordx4 v[64:67], v10, s[36:39], s52 offen sc1
v_cmp_gt_u32 vcc, 8, v6
s_and_saveexec_b64 s[64:65], vcc
buffer_store_dwordx4 v[68:71], v10, s[36:39], s52 offen offset:512 sc1
s_mov_b64 exec, -1
v_min_u32 v10, 47, v0
v_lshlrev_b32 v10, 4, v10
s_lshl_b32 s52, s48, 14
s_add_u32 s52, s52, 65536
s_mov_b32 s70, 0
s_add_u32 s53, s52, 0
buffer_load_dwordx4 v[96:99], v10, s[36:39], s53 offen offset:0 sc1
buffer_load_dwordx4 v[100:103], v10, s[36:39], s53 offen offset:768 sc1
s_add_u32 s53, s52, 2048
buffer_load_dwordx4 v[104:107], v10, s[36:39], s53 offen offset:0 sc1
buffer_load_dwordx4 v[108:111], v10, s[36:39], s53 offen offset:768 sc1
s_add_u32 s53, s52, 4096
buffer_load_dwordx4 v[112:115], v10, s[36:39], s53 offen offset:0 sc1
buffer_load_dwordx4 v[116:119], v10, s[36:39], s53 offen offset:768 sc1
s_add_u32 s53, s52, 6144
buffer_load_dwordx4 v[120:123], v10, s[36:39], s53 offen offset:0 sc1
buffer_load_dwordx4 v[124:127], v10, s[36:39], s53 offen offset:768 sc1
s_add_u32 s53, s52, 8192
buffer_load_dwordx4 v[128:131], v10, s[36:39], s53 offen offset:0 sc1
buffer_load_dwordx4 v[132:135], v10, s[36:39], s53 offen offset:768 sc1
s_add_u32 s53, s52, 10240
buffer_load_dwordx4 v[136:139], v10, s[36:39], s53 offen offset:0 sc1
buffer_load_dwordx4 v[140:143], v10, s[36:39], s53 offen offset:768 sc1
s_add_u32 s53, s52, 12288
buffer_load_dwordx4 v[144:147], v10, s[36:39], s53 offen offset:0 sc1
buffer_load_dwordx4 v[148:151], v10, s[36:39], s53 offen offset:768 sc1
s_add_u32 s53, s52, 14336
buffer_load_dwordx4 v[152:155], v10, s[36:39], s53 offen offset:0 sc1
buffer_load_dwordx4 v[156:159], v10, s[36:39], s53 offen offset:768 sc1
s_mov_b32 s66, 0
L_qpoll:
s_waitcnt vmcnt(0)
s_bitcmp1_b32 s70, 0
s_cbranch_scc1 L_qc_25
v_msad_u8 v13, v96, v18, 0
v_msad_u8 v13, v97, v18, v13
v_msad_u8 v13, v98, v18, v13
v_msad_u8 v13, v99, v18, v13
v_msad_u8 v13, v100, v18, v13
v_msad_u8 v13, v101, v18, v13
v_msad_u8 v13, v102, v18, v13
v_msad_u8 v13, v103, v18, v13
v_cmp_ne_u32 vcc, 0, v13
s_cbranch_vccnz L_qc_25
s_bitset1_b32 s70, 0
L_qc_25:
s_bitcmp1_b32 s70, 1
s_cbranch_scc1 L_qc_26
v_msad_u8 v13, v104, v18, 0
v_msad_u8 v13, v105, v18, v13
v_msad_u8 v13, v106, v18, v13
v_msad_u8 v13, v107, v18, v13
v_msad_u8 v13, v108, v18, v13
v_msad_u8 v13, v109, v18, v13
v_msad_u8 v13, v110, v18, v13
v_msad_u8 v13, v111, v18, v13
v_cmp_ne_u32 vcc, 0, v13
s_cbranch_vccnz L_qc_26
s_bitset1_b32 s70, 1
L_qc_26:
s_bitcmp1_b32 s70, 2
s_cbranch_scc1 L_qc_27
v_msad_u8 v13, v112, v18, 0
v_msad_u8 v13, v113, v18, v13
v_msad_u8 v13, v114, v18, v13
v_msad_u8 v13, v115, v18, v13
v_msad_u8 v13, v116, v18, v13
v_msad_u8 v13, v117, v18, v13
v_msad_u8 v13, v118, v18, v13
v_msad_u8 v13, v119, v18, v13
v_cmp_ne_u32 vcc, 0, v13
s_cbranch_vccnz L_qc_27
s_bitset1_b32 s70, 2
L_qc_27:
s_bitcmp1_b32 s70, 3
s_cbranch_scc1 L_qc_28
v_msad_u8 v13, v120, v18, 0
v_msad_u8 v13, v121, v18, v13
v_msad_u8 v13, v122, v18, v13
v_msad_u8 v13, v123, v18, v13
v_msad_u8 v13, v124, v18, v13
v_msad_u8 v13, v125, v18, v13
v_msad_u8 v13, v126, v18, v13
v_msad_u8 v13, v127, v18, v13
v_cmp_ne_u32 vcc, 0, v13
s_cbranch_vccnz L_qc_28
s_bitset1_b32 s70, 3
L_qc_28:
s_bitcmp1_b32 s70, 4
s_cbranch_scc1 L_qc_29
v_msad_u8 v13, v128, v18, 0
v_msad_u8 v13, v129, v18, v13
v_msad_u8 v13, v130, v18, v13
v_msad_u8 v13, v131, v18, v13
v_msad_u8 v13, v132, v18, v13
v_msad_u8 v13, v133, v18, v13
v_msad_u8 v13, v134, v18, v13
v_msad_u8 v13, v135, v18, v13
v_cmp_ne_u32 vcc, 0, v13
s_cbranch_vccnz L_qc_29
s_bitset1_b32 s70, 4
L_qc_29:
s_bitcmp1_b32 s70, 5
s_cbranch_scc1 L_qc_30
v_msad_u8 v13, v136, v18, 0
v_msad_u8 v13, v137, v18, v13
v_msad_u8 v13, v138, v18, v13
v_msad_u8 v13, v139, v18, v13
v_msad_u8 v13, v140, v18, v13
v_msad_u8 v13, v141, v18, v13
v_msad_u8 v13, v142, v18, v13
v_msad_u8 v13, v143, v18, v13
v_cmp_ne_u32 vcc, 0, v13
s_cbranch_vccnz L_qc_30
s_bitset1_b32 s70, 5
L_qc_30:
s_bitcmp1_b32 s70, 6
s_cbranch_scc1 L_qc_31
v_msad_u8 v13, v144, v18, 0
v_msad_u8 v13, v145, v18, v13
v_msad_u8 v13, v146, v18, v13
v_msad_u8 v13, v147, v18, v13
v_msad_u8 v13, v148, v18, v13
v_msad_u8 v13, v149, v18, v13
v_msad_u8 v13, v150, v18, v13
v_msad_u8 v13, v151, v18, v13
v_cmp_ne_u32 vcc, 0, v13
s_cbranch_vccnz L_qc_31
s_bitset1_b32 s70, 6
L_qc_31:
s_bitcmp1_b32 s70, 7
s_cbranch_scc1 L_qc_32
v_msad_u8 v13, v152, v18, 0
v_msad_u8 v13, v153, v18, v13
v_msad_u8 v13, v154, v18, v13
v_msad_u8 v13, v155, v18, v13
v_msad_u8 v13, v156, v18, v13
v_msad_u8 v13, v157, v18, v13
v_msad_u8 v13, v158, v18, v13
v_msad_u8 v13, v159, v18, v13
v_cmp_ne_u32 vcc, 0, v13
s_cbranch_vccnz L_qc_32
s_bitset1_b32 s70, 7
L_qc_32:
s_cmp_eq_u32 s70, 0xff
s_cbranch_scc1 L_qok
s_bitcmp1_b32 s70, 0
s_cbranch_scc1 L_qi_33
s_add_u32 s53, s52, 0
buffer_load_dwordx4 v[96:99], v10, s[36:39], s53 offen offset:0 sc1
buffer_load_dwordx4 v[100:103], v10, s[36:39], s53 offen offset:768 sc1
L_qi_33:
s_bitcmp1_b32 s70, 1
s_cbranch_scc1 L_qi_34
s_add_u32 s53, s52, 2048
buffer_load_dwordx4 v[104:107], v10, s[36:39], s53 offen offset:0 sc1
buffer_load_dwordx4 v[108:111], v10, s[36:39], s53 offen offset:768 sc1
L_qi_34:
s_bitcmp1_b32 s70, 2
s_cbranch_scc1 L_qi_35
s_add_u32 s53, s52, 4096
buffer_load_dwordx4 v[112:115], v10, s[36:39], s53 offen offset:0 sc1
buffer_load_dwordx4 v[116:119], v10, s[36:39], s53 offen offset:768 sc1
L_qi_35:
s_bitcmp1_b32 s70, 3
s_cbranch_scc1 L_qi_36
s_add_u32 s53, s52, 6144
buffer_load_dwordx4 v[120:123], v10, s[36:39], s53 offen offset:0 sc1
buffer_load_dwordx4 v[124:127], v10, s[36:39], s53 offen offset:768 sc1
L_qi_36:
s_bitcmp1_b32 s70, 4
s_cbranch_scc1 L_qi_37
s_add_u32 s53, s52, 8192
buffer_load_dwordx4 v[128:131], v10, s[36:39], s53 offen offset:0 sc1
buffer_load_dwordx4 v[132:135], v10, s[36:39], s53 offen offset:768 sc1
L_qi_37:
s_bitcmp1_b32 s70, 5
s_cbranch_scc1 L_qi_38
s_add_u32 s53, s52, 10240
buffer_load_dwordx4 v[136:139], v10, s[36:39], s53 offen offset:0 sc1
buffer_load_dwordx4 v[140:143], v10, s[36:39], s53 offen offset:768 sc1
L_qi_38:
s_bitcmp1_b32 s70, 6
s_cbranch_scc1 L_qi_39
s_add_u32 s53, s52, 12288
buffer_load_dwordx4 v[144:147], v10, s[36:39], s53 offen offset:0 sc1
buffer_load_dwordx4 v[148:151], v10, s[36:39], s53 offen offset:768 sc1
L_qi_39:
s_bitcmp1_b32 s70, 7
s_cbranch_scc1 L_qi_40
s_add_u32 s53, s52, 14336
buffer_load_dwordx4 v[152:155], v10, s[36:39], s53 offen offset:0 sc1
buffer_load_dwordx4 v[156:159], v10, s[36:39], s53 offen offset:768 sc1
L_qi_40:
s_add_u32 s66, s66, 1
s_cmp_lt_u32 s66, 200000
s_cbranch_scc1 L_qpoll
s_waitcnt vmcnt(0)
L_qok:
v_add_f32 v96, v96, v104
v_add_f32 v97, v97, v105
v_add_f32 v98, v98, v106
v_add_f32 v99, v99, v107
v_add_f32 v100, v100, v108
v_add_f32 v101, v101, v109
v_add_f32 v102, v102, v110
v_add_f32 v103, v103, v111
v_add_f32 v112, v112, v120
v_add_f32 v113, v113, v121
v_add_f32 v114, v114, v122
v_add_f32 v115, v115, v123
v_add_f32 v116, v116, v124
v_add_f32 v117, v117, v125
v_add_f32 v118, v118, v126
v_add_f32 v119, v119, v127
v_add_f32 v128, v128, v136
v_add_f32 v129, v129, v137
v_add_f32 v130, v130, v138
v_add_f32 v131, v131, v139
v_add_f32 v132, v132, v140
v_add_f32 v133, v133, v141
v_add_f32 v134, v134, v142
v_add_f32 v135, v135, v143
v_add_f32 v144, v144, v152
v_add_f32 v145, v145, v153
v_add_f32 v146, v146, v154
v_add_f32 v147, v147, v155
v_add_f32 v148, v148, v156
v_add_f32 v149, v149, v157
v_add_f32 v150, v150, v158
v_add_f32 v151, v151, v159
v_add_f32 v96, v96, v112
v_add_f32 v97, v97, v113
v_add_f32 v98, v98, v114
v_add_f32 v99, v99, v115
v_add_f32 v100, v100, v116
v_add_f32 v101, v101, v117
v_add_f32 v102, v102, v118
v_add_f32 v103, v103, v119
v_add_f32 v128, v128, v144
v_add_f32 v129, v129, v145
v_add_f32 v130, v130, v146
v_add_f32 v131, v131, v147
v_add_f32 v132, v132, v148
v_add_f32 v133, v133, v149
v_add_f32 v134, v134, v150
v_add_f32 v135, v135, v151
v_add_f32 v96, v96, v128
v_add_f32 v97, v97, v129
v_add_f32 v98, v98, v130
v_add_f32 v99, v99, v131
v_add_f32 v100, v100, v132
v_add_f32 v101, v101, v133
v_add_f32 v102, v102, v134
v_add_f32 v103, v103, v135
v_cvt_pk_bf16_f32 v104, v96, v97
v_cvt_pk_bf16_f32 v105, v98, v99
v_cvt_pk_bf16_f32 v106, v100, v101
v_cvt_pk_bf16_f32 v107, v102, v103
v_lshrrev_b32 v10, 1, v10
v_cmp_gt_u32 vcc, 48, v0
s_and_saveexec_b64 s[64:65], vcc
ds_write_b64 v10, v[104:105] offset:2560
ds_write_b64 v10, v[106:107] offset:2944
s_mov_b64 exec, -1
v_mov_b32 v12, 3584
ds_write_b32 v12, v16
s_waitcnt lgkmcnt(0)
s_barrier
s_setprio 0
v_cmp_gt_u32 vcc, 6, v6
v_subrev_u32 v11, 6, v6
v_mov_b32 v14, s18
v_mov_b32 v15, s19
v_mov_b32 v12, s16
v_mov_b32 v13, s17
v_cndmask_b32 v11, v11, v6, vcc
v_cndmask_b32 v14, v14, v12, vcc
v_cndmask_b32 v15, v15, v13, vcc
v_mul_u32_u24 v10, 3072, v7
v_lshl_add_u32 v10, v11, 4, v10
s_mul_i32 s52, s49, 245760
s_mul_i32 s53, s48, 96
s_add_u32 s52, s52, s53
v_add_u32 v10, s52, v10
v_mov_b32 v11, 0
v_add_co_u32 v14, vcc, v14, v10
s_nop 1
v_addc_co_u32 v15, vcc, v15, v11, vcc
s_mov_b32 s54, 12288
s_mov_b32 s55, 0
s_mov_b32 s70, 0x0fff0fff
s_mov_b32 s71, 0x0fff0fff
s_mov_b64 exec, s[70:71]
global_load_dwordx4 v[96:99], v[14:15], off nt
v_lshl_add_u64 v[14:15], v[14:15], 0, s[54:55]
global_load_dwordx4 v[100:103], v[14:15], off nt
v_lshl_add_u64 v[14:15], v[14:15], 0, s[54:55]
global_load_dwordx4 v[104:107], v[14:15], off nt
v_lshl_add_u64 v[14:15], v[14:15], 0, s[54:55]
global_load_dwordx4 v[108:111], v[14:15], off nt
v_lshl_add_u64 v[14:15], v[14:15], 0, s[54:55]
global_load_dwordx4 v[112:115], v[14:15], off nt
v_lshl_add_u64 v[14:15], v[14:15], 0, s[54:55]
global_load_dwordx4 v[116:119], v[14:15], off nt
v_lshl_add_u64 v[14:15], v[14:15], 0, s[54:55]
global_load_dwordx4 v[120:123], v[14:15], off nt
v_lshl_add_u64 v[14:15], v[14:15], 0, s[54:55]
global_load_dwordx4 v[124:127], v[14:15], off nt
v_lshl_add_u64 v[14:15], v[14:15], 0, s[54:55]
global_load_dwordx4 v[128:131], v[14:15], off nt
v_lshl_add_u64 v[14:15], v[14:15], 0, s[54:55]
global_load_dwordx4 v[132:135], v[14:15], off nt
v_lshl_add_u64 v[14:15], v[14:15], 0, s[54:55]
global_load_dwordx4 v[136:139], v[14:15], off nt
v_lshl_add_u64 v[14:15], v[14:15], 0, s[54:55]
global_load_dwordx4 v[140:143], v[14:15], off nt
v_lshl_add_u64 v[14:15], v[14:15], 0, s[54:55]
global_load_dwordx4 v[144:147], v[14:15], off nt
v_lshl_add_u64 v[14:15], v[14:15], 0, s[54:55]
global_load_dwordx4 v[148:151], v[14:15], off nt
v_lshl_add_u64 v[14:15], v[14:15], 0, s[54:55]
global_load_dwordx4 v[152:155], v[14:15], off nt
v_lshl_add_u64 v[14:15], v[14:15], 0, s[54:55]
global_load_dwordx4 v[156:159], v[14:15], off nt
v_lshl_add_u64 v[14:15], v[14:15], 0, s[54:55]
global_load_dwordx4 v[160:163], v[14:15], off nt
v_lshl_add_u64 v[14:15], v[14:15], 0, s[54:55]
global_load_dwordx4 v[164:167], v[14:15], off nt
v_lshl_add_u64 v[14:15], v[14:15], 0, s[54:55]
global_load_dwordx4 v[168:171], v[14:15], off nt
v_lshl_add_u64 v[14:15], v[14:15], 0, s[54:55]
global_load_dwordx4 v[172:175], v[14:15], off nt
s_mov_b64 exec, -1
s_mul_i32 s52, s49, 320
v_lshl_add_u32 v3, v7, 2, s52
ds_read_b32 v44, v3 offset:0
ds_read_b32 v45, v3 offset:16
ds_read_b32 v46, v3 offset:32
ds_read_b32 v47, v3 offset:48
ds_read_b32 v48, v3 offset:64
ds_read_b32 v49, v3 offset:80
ds_read_b32 v50, v3 offset:96
ds_read_b32 v51, v3 offset:112
ds_read_b32 v52, v3 offset:128
ds_read_b32 v53, v3 offset:144
ds_read_b32 v54, v3 offset:160
ds_read_b32 v55, v3 offset:176
ds_read_b32 v56, v3 offset:192
ds_read_b32 v57, v3 offset:208
ds_read_b32 v58, v3 offset:224
ds_read_b32 v59, v3 offset:240
ds_read_b32 v60, v3 offset:256
ds_read_b32 v61, v3 offset:272
ds_read_b32 v62, v3 offset:288
ds_read_b32 v63, v3 offset:304
s_waitcnt vmcnt(0) lgkmcnt(0)
v_perm_b32 v76, v44, v44, v20
v_perm_b32 v77, v44, v44, v21
v_perm_b32 v78, v44, v44, v22
v_perm_b32 v79, v44, v44, v23
s_nop 1
v_mfma_f32_16x16x32_bf16 v[64:67], v[76:79], v[96:99], 0
v_perm_b32 v80, v45, v45, v20
v_perm_b32 v81, v45, v45, v21
v_perm_b32 v82, v45, v45, v22
v_perm_b32 v83, v45, v45, v23
s_nop 1
v_mfma_f32_16x16x32_bf16 v[64:67], v[80:83], v[100:103], v[64:67]
v_perm_b32 v76, v46, v46, v20
v_perm_b32 v77, v46, v46, v21
v_perm_b32 v78, v46, v46, v22
v_perm_b32 v79, v46, v46, v23
s_nop 1
v_mfma_f32_16x16x32_bf16 v[64:67], v[76:79], v[104:107], v[64:67]
v_perm_b32 v80, v47, v47, v20
v_perm_b32 v81, v47, v47, v21
v_perm_b32 v82, v47, v47, v22
v_perm_b32 v83, v47, v47, v23
s_nop 1
v_mfma_f32_16x16x32_bf16 v[64:67], v[80:83], v[108:111], v[64:67]
v_perm_b32 v76, v48, v48, v20
v_perm_b32 v77, v48, v48, v21
v_perm_b32 v78, v48, v48, v22
v_perm_b32 v79, v48, v48, v23
s_nop 1
v_mfma_f32_16x16x32_bf16 v[64:67], v[76:79], v[112:115], v[64:67]
v_perm_b32 v80, v49, v49, v20
v_perm_b32 v81, v49, v49, v21
v_perm_b32 v82, v49, v49, v22
v_perm_b32 v83, v49, v49, v23
s_nop 1
v_mfma_f32_16x16x32_bf16 v[64:67], v[80:83], v[116:119], v[64:67]
v_perm_b32 v76, v50, v50, v20
v_perm_b32 v77, v50, v50, v21
v_perm_b32 v78, v50, v50, v22
v_perm_b32 v79, v50, v50, v23
s_nop 1
v_mfma_f32_16x16x32_bf16 v[64:67], v[76:79], v[120:123], v[64:67]
v_perm_b32 v80, v51, v51, v20
v_perm_b32 v81, v51, v51, v21
v_perm_b32 v82, v51, v51, v22
v_perm_b32 v83, v51, v51, v23
s_nop 1
v_mfma_f32_16x16x32_bf16 v[64:67], v[80:83], v[124:127], v[64:67]
v_perm_b32 v76, v52, v52, v20
v_perm_b32 v77, v52, v52, v21
v_perm_b32 v78, v52, v52, v22
v_perm_b32 v79, v52, v52, v23
s_nop 1
v_mfma_f32_16x16x32_bf16 v[64:67], v[76:79], v[128:131], v[64:67]
v_perm_b32 v80, v53, v53, v20
v_perm_b32 v81, v53, v53, v21
v_perm_b32 v82, v53, v53, v22
v_perm_b32 v83, v53, v53, v23
s_nop 1
v_mfma_f32_16x16x32_bf16 v[64:67], v[80:83], v[132:135], v[64:67]
v_perm_b32 v76, v54, v54, v20
v_perm_b32 v77, v54, v54, v21
v_perm_b32 v78, v54, v54, v22
v_perm_b32 v79, v54, v54, v23
s_nop 1
v_mfma_f32_16x16x32_bf16 v[64:67], v[76:79], v[136:139], v[64:67]
v_perm_b32 v80, v55, v55, v20
v_perm_b32 v81, v55, v55, v21
v_perm_b32 v82, v55, v55, v22
v_perm_b32 v83, v55, v55, v23
s_nop 1
v_mfma_f32_16x16x32_bf16 v[64:67], v[80:83], v[140:143], v[64:67]
v_perm_b32 v76, v56, v56, v20
v_perm_b32 v77, v56, v56, v21
v_perm_b32 v78, v56, v56, v22
v_perm_b32 v79, v56, v56, v23
s_nop 1
v_mfma_f32_16x16x32_bf16 v[64:67], v[76:79], v[144:147], v[64:67]
v_perm_b32 v80, v57, v57, v20
v_perm_b32 v81, v57, v57, v21
v_perm_b32 v82, v57, v57, v22
v_perm_b32 v83, v57, v57, v23
s_nop 1
v_mfma_f32_16x16x32_bf16 v[64:67], v[80:83], v[148:151], v[64:67]
v_perm_b32 v76, v58, v58, v20
v_perm_b32 v77, v58, v58, v21
v_perm_b32 v78, v58, v58, v22
v_perm_b32 v79, v58, v58, v23
s_nop 1
v_mfma_f32_16x16x32_bf16 v[64:67], v[76:79], v[152:155], v[64:67]
v_perm_b32 v80, v59, v59, v20
v_perm_b32 v81, v59, v59, v21
v_perm_b32 v82, v59, v59, v22
v_perm_b32 v83, v59, v59, v23
s_nop 1
v_mfma_f32_16x16x32_bf16 v[64:67], v[80:83], v[156:159], v[64:67]
v_perm_b32 v76, v60, v60, v20
v_perm_b32 v77, v60, v60, v21
v_perm_b32 v78, v60, v60, v22
v_perm_b32 v79, v60, v60, v23
s_nop 1
v_mfma_f32_16x16x32_bf16 v[64:67], v[76:79], v[160:163], v[64:67]
v_perm_b32 v80, v61, v61, v20
v_perm_b32 v81, v61, v61, v21
v_perm_b32 v82, v61, v61, v22
v_perm_b32 v83, v61, v61, v23
s_nop 1
v_mfma_f32_16x16x32_bf16 v[64:67], v[80:83], v[164:167], v[64:67]
v_perm_b32 v76, v62, v62, v20
v_perm_b32 v77, v62, v62, v21
v_perm_b32 v78, v62, v62, v22
v_perm_b32 v79, v62, v62, v23
s_nop 1
v_mfma_f32_16x16x32_bf16 v[64:67], v[76:79], v[168:171], v[64:67]
v_perm_b32 v80, v63, v63, v20
v_perm_b32 v81, v63, v63, v21
v_perm_b32 v82, v63, v63, v22
v_perm_b32 v83, v63, v63, v23
s_nop 1
v_mfma_f32_16x16x32_bf16 v[64:67], v[80:83], v[172:175], v[64:67]
v_lshrrev_b32 v10, 5, v0
v_mul_u32_u24 v10, 384, v10
v_lshl_add_u32 v10, v6, 5, v10
v_and_b32 v11, 1, v7
v_lshl_add_u32 v10, v11, 4, v10
s_lshl_b32 s52, s2, 10
s_add_u32 s52, s52, 589824
s_nop 2
s_mov_b64 exec, s[70:71]
buffer_store_dwordx4 v[64:67], v10, s[36:39], s52 offen sc1
s_mov_b64 exec, -1
s_waitcnt vmcnt(0)
s_lshl_b32 s52, s48, 8
s_add_u32 s52, s52, 49152
s_lshl_b32 s53, s49, 2
v_mov_b32 v12, s53
s_mov_b64 exec, 1
buffer_store_dword v17, v12, s[36:39], s52 offen sc1
s_mov_b64 exec, -1
s_cmp_ge_u32 s49, 5
s_cbranch_scc1 L_noffn
s_mov_b32 s40, s20
s_and_b32 s41, s21, 0xffff
s_mov_b32 s42, 1966080
s_mov_b32 s43, 0x20000
v_mul_u32_u24 v11, 1280, v7
v_lshl_add_u32 v11, v6, 4, v11
s_mul_i32 s53, s48, 61440
s_lshl_b32 s54, s49, 8
s_add_u32 s53, s53, s54
buffer_load_dwordx4 v[160:163], v11, s[40:43], s53 offen nt
s_add_u32 s53, s53, 5120
buffer_load_dwordx4 v[164:167], v11, s[40:43], s53 offen nt
s_add_u32 s53, s53, 5120
buffer_load_dwordx4 v[168:171], v11, s[40:43], s53 offen nt
s_add_u32 s53, s53, 5120
buffer_load_dwordx4 v[172:175], v11, s[40:43], s53 offen nt
s_add_u32 s53, s53, 5120
buffer_load_dwordx4 v[176:179], v11, s[40:43], s53 offen nt
s_add_u32 s53, s53, 5120
buffer_load_dwordx4 v[180:183], v11, s[40:43], s53 offen nt
s_add_u32 s53, s53, 5120
buffer_load_dwordx4 v[184:187], v11, s[40:43], s53 offen nt
s_add_u32 s53, s53, 5120
buffer_load_dwordx4 v[188:191], v11, s[40:43], s53 offen nt
s_add_u32 s53, s53, 5120
buffer_load_dwordx4 v[192:195], v11, s[40:43], s53 offen nt
s_add_u32 s53, s53, 5120
buffer_load_dwordx4 v[196:199], v11, s[40:43], s53 offen nt
s_add_u32 s53, s53, 5120
buffer_load_dwordx4 v[200:203], v11, s[40:43], s53 offen nt
s_add_u32 s53, s53, 5120
buffer_load_dwordx4 v[204:207], v11, s[40:43], s53 offen nt
v_and_b32 v12, 7, v0
v_lshlrev_b32 v12, 2, v12
s_mov_b32 s66, 0
L_f2poll:
buffer_load_dword v13, v12, s[36:39], s52 offen sc1
s_waitcnt vmcnt(0)
v_cmp_ne_u32 vcc, v13, v17
s_cbranch_vccz L_f2ok
s_add_u32 s66, s66, 1
s_sleep 8
s_cmp_lt_u32 s66, 200000
s_cbranch_scc1 L_f2poll
L_f2ok:
s_lshl_b32 s52, s48, 13
s_add_u32 s52, s52, 589824
s_add_u32 s53, s52, 4096
s_mov_b64 exec, s[70:71]
buffer_load_dwordx4 v[96:99], v10, s[36:39], s52 offen offset:0 sc1
buffer_load_dwordx4 v[100:103], v10, s[36:39], s52 offen offset:1024 sc1
buffer_load_dwordx4 v[104:107], v10, s[36:39], s52 offen offset:2048 sc1
buffer_load_dwordx4 v[108:111], v10, s[36:39], s52 offen offset:3072 sc1
buffer_load_dwordx4 v[112:115], v10, s[36:39], s53 offen offset:0 sc1
buffer_load_dwordx4 v[116:119], v10, s[36:39], s53 offen offset:1024 sc1
buffer_load_dwordx4 v[120:123], v10, s[36:39], s53 offen offset:2048 sc1
buffer_load_dwordx4 v[124:127], v10, s[36:39], s53 offen offset:3072 sc1
s_mov_b64 exec, -1
s_waitcnt vmcnt(0)
v_add_f32 v96, v96, v100
v_add_f32 v97, v97, v101
v_add_f32 v98, v98, v102
v_add_f32 v99, v99, v103
v_add_f32 v104, v104, v108
v_add_f32 v105, v105, v109
v_add_f32 v106, v106, v110
v_add_f32 v107, v107, v111
v_add_f32 v112, v112, v116
v_add_f32 v113, v113, v117
v_add_f32 v114, v114, v118
v_add_f32 v115, v115, v119
v_add_f32 v120, v120, v124
v_add_f32 v121, v121, v125
v_add_f32 v122, v122, v126
v_add_f32 v123, v123, v127
v_add_f32 v96, v96, v104
v_add_f32 v97, v97, v105
v_add_f32 v98, v98, v106
v_add_f32 v99, v99, v107
v_add_f32 v112, v112, v120
v_add_f32 v113, v113, v121
v_add_f32 v114, v114, v122
v_add_f32 v115, v115, v123
v_add_f32 v96, v96, v112
v_add_f32 v97, v97, v113
v_add_f32 v98, v98, v114
v_add_f32 v99, v99, v115
s_nop 0
v_mov_b32_dpp v44, v96 row_shl:6 row_mask:0xf bank_mask:0xf
v_mov_b32_dpp v45, v97 row_shl:6 row_mask:0xf bank_mask:0xf
v_mov_b32_dpp v46, v98 row_shl:6 row_mask:0xf bank_mask:0xf
v_mov_b32_dpp v47, v99 row_shl:6 row_mask:0xf bank_mask:0xf
v_cvt_pk_bf16_f32 v19, v96, v97
v_lshlrev_b32 v96, 16, v19
v_and_b32 v97, 0xffff0000, v19
v_cvt_pk_bf16_f32 v19, v98, v99
v_lshlrev_b32 v98, 16, v19
v_and_b32 v99, 0xffff0000, v19
v_cvt_pk_bf16_f32 v19, v44, v45
v_lshlrev_b32 v44, 16, v19
v_and_b32 v45, 0xffff0000, v19
v_cvt_pk_bf16_f32 v19, v46, v47
v_lshlrev_b32 v46, 16, v19
v_and_b32 v47, 0xffff0000, v19
v_mul_f32 v50, 0xbfb8aa3b, v96
v_exp_f32 v50, v50
s_nop 0
v_add_f32 v50, 1.0, v50
v_rcp_f32 v50, v50
s_nop 0
v_mul_f32 v96, v96, v50
v_mul_f32 v50, 0xbfb8aa3b, v97
v_exp_f32 v50, v50
s_nop 0
v_add_f32 v50, 1.0, v50
v_rcp_f32 v50, v50
s_nop 0
v_mul_f32 v97, v97, v50
v_mul_f32 v50, 0xbfb8aa3b, v98
v_exp_f32 v50, v50
s_nop 0
v_add_f32 v50, 1.0, v50
v_rcp_f32 v50, v50
s_nop 0
v_mul_f32 v98, v98, v50
v_mul_f32 v50, 0xbfb8aa3b, v99
v_exp_f32 v50, v50
s_nop 0
v_add_f32 v50, 1.0, v50
v_rcp_f32 v50, v50
s_nop 0
v_mul_f32 v99, v99, v50
v_cvt_pk_bf16_f32 v19, v96, v97
v_lshlrev_b32 v96, 16, v19
v_and_b32 v97, 0xffff0000, v19
v_cvt_pk_bf16_f32 v19, v98, v99
v_lshlrev_b32 v98, 16, v19
v_and_b32 v99, 0xffff0000, v19
v_mul_f32 v96, v96, v44
v_mul_f32 v97, v97, v45
v_mul_f32 v98, v98, v46
v_mul_f32 v99, v99, v47
v_cvt_pk_bf16_f32 v44, v96, v97
v_cvt_pk_bf16_f32 v46, v98, v99
v_lshrrev_b32 v45, 16, v44
v_lshrrev_b32 v47, 16, v46
v_lshlrev_b32 v10, 5, v6
v_and_b32 v11, 1, v7
v_lshl_add_u32 v10, v11, 4, v10
v_lshrrev_b32 v11, 1, v7
v_lshl_add_u32 v10, v11, 1, v10
v_cmp_gt_u32 vcc, 6, v6
s_and_saveexec_b64 s[64:65], vcc
ds_write_b16 v10, v44 offset:3328
ds_write_b16 v10, v45 offset:3332
ds_write_b16 v10, v46 offset:3336
ds_write_b16 v10, v47 offset:3340
s_mov_b64 exec, -1
s_waitcnt lgkmcnt(0)
v_lshlrev_b32 v3, 2, v7
ds_read_b32 v44, v3 offset:3328
ds_read_b32 v45, v3 offset:3344
ds_read_b32 v46, v3 offset:3360
ds_read_b32 v47, v3 offset:3376
ds_read_b32 v48, v3 offset:3392
ds_read_b32 v49, v3 offset:3408
ds_read_b32 v50, v3 offset:3424
ds_read_b32 v51, v3 offset:3440
ds_read_b32 v52, v3 offset:3456
ds_read_b32 v53, v3 offset:3472
ds_read_b32 v54, v3 offset:3488
ds_read_b32 v55, v3 offset:3504
s_waitcnt lgkmcnt(0)
v_perm_b32 v76, v44, v44, v20
v_perm_b32 v77, v44, v44, v21
v_perm_b32 v78, v44, v44, v22
v_perm_b32 v79, v44, v44, v23
s_nop 1
v_mfma_f32_16x16x32_bf16 v[64:67], v[76:79], v[160:163], 0
v_perm_b32 v80, v45, v45, v20
v_perm_b32 v81, v45, v45, v21
v_perm_b32 v82, v45, v45, v22
v_perm_b32 v83, v45, v45, v23
s_nop 1
v_mfma_f32_16x16x32_bf16 v[64:67], v[80:83], v[164:167], v[64:67]
v_perm_b32 v76, v46, v46, v20
v_perm_b32 v77, v46, v46, v21
v_perm_b32 v78, v46, v46, v22
v_perm_b32 v79, v46, v46, v23
s_nop 1
v_mfma_f32_16x16x32_bf16 v[64:67], v[76:79], v[168:171], v[64:67]
v_perm_b32 v80, v47, v47, v20
v_perm_b32 v81, v47, v47, v21
v_perm_b32 v82, v47, v47, v22
v_perm_b32 v83, v47, v47, v23
s_nop 1
v_mfma_f32_16x16x32_bf16 v[64:67], v[80:83], v[172:175], v[64:67]
v_perm_b32 v76, v48, v48, v20
v_perm_b32 v77, v48, v48, v21
v_perm_b32 v78, v48, v48, v22
v_perm_b32 v79, v48, v48, v23
s_nop 1
v_mfma_f32_16x16x32_bf16 v[64:67], v[76:79], v[176:179], v[64:67]
v_perm_b32 v80, v49, v49, v20
v_perm_b32 v81, v49, v49, v21
v_perm_b32 v82, v49, v49, v22
v_perm_b32 v83, v49, v49, v23
s_nop 1
v_mfma_f32_16x16x32_bf16 v[64:67], v[80:83], v[180:183], v[64:67]
v_perm_b32 v76, v50, v50, v20
v_perm_b32 v77, v50, v50, v21
v_perm_b32 v78, v50, v50, v22
v_perm_b32 v79, v50, v50, v23
s_nop 1
v_mfma_f32_16x16x32_bf16 v[64:67], v[76:79], v[184:187], v[64:67]
v_perm_b32 v80, v51, v51, v20
v_perm_b32 v81, v51, v51, v21
v_perm_b32 v82, v51, v51, v22
v_perm_b32 v83, v51, v51, v23
s_nop 1
v_mfma_f32_16x16x32_bf16 v[64:67], v[80:83], v[188:191], v[64:67]
v_perm_b32 v76, v52, v52, v20
v_perm_b32 v77, v52, v52, v21
v_perm_b32 v78, v52, v52, v22
v_perm_b32 v79, v52, v52, v23
s_nop 1
v_mfma_f32_16x16x32_bf16 v[64:67], v[76:79], v[192:195], v[64:67]
v_perm_b32 v80, v53, v53, v20
v_perm_b32 v81, v53, v53, v21
v_perm_b32 v82, v53, v53, v22
v_perm_b32 v83, v53, v53, v23
s_nop 1
v_mfma_f32_16x16x32_bf16 v[64:67], v[80:83], v[196:199], v[64:67]
v_perm_b32 v76, v54, v54, v20
v_perm_b32 v77, v54, v54, v21
v_perm_b32 v78, v54, v54, v22
v_perm_b32 v79, v54, v54, v23
s_nop 1
v_mfma_f32_16x16x32_bf16 v[64:67], v[76:79], v[200:203], v[64:67]
v_perm_b32 v80, v55, v55, v20
v_perm_b32 v81, v55, v55, v21
v_perm_b32 v82, v55, v55, v22
v_perm_b32 v83, v55, v55, v23
s_nop 1
v_mfma_f32_16x16x32_bf16 v[64:67], v[80:83], v[204:207], v[64:67]
v_lshrrev_b32 v10, 5, v0
v_lshlrev_b32 v10, 9, v10
v_lshl_add_u32 v10, v6, 5, v10
v_and_b32 v11, 1, v7
v_lshl_add_u32 v10, v11, 4, v10
s_lshl_b32 s52, s49, 5
s_add_u32 s52, s52, s48
s_lshl_b32 s52, s52, 10
s_add_u32 s52, s52, 2359296
v_min_u32 v64, 0xfffffffe, v64
v_min_u32 v65, 0xfffffffe, v65
v_min_u32 v66, 0xfffffffe, v66
v_min_u32 v67, 0xfffffffe, v67
buffer_store_dwordx4 v[64:67], v10, s[36:39], s52 offen sc1
L_noffn:
s_cmp_eq_u32 s48, s49
s_cselect_b32 s69, 1, 0
s_cmp_lt_u32 s49, 5
s_cselect_b32 s69, s69, 0
s_cmp_eq_u32 s69, 0
s_cbranch_scc1 L_nofinprep
v_lshrrev_b32 v10, 1, v0
v_lshlrev_b32 v10, 8, v10
v_and_b32 v11, 1, v0
v_lshl_add_u32 v10, v11, 4, v10
s_mov_b32 s52, 49152
s_mov_b32 s66, 0
L_allq:
buffer_load_dwordx4 v[44:47], v10, s[36:39], s52 offen sc1
s_waitcnt vmcnt(0)
v_xor_b32 v44, v44, v17
v_xor_b32 v45, v45, v17
v_xor_b32 v46, v46, v17
v_xor_b32 v47, v47, v17
v_or3_b32 v44, v44, v45, v46
v_or_b32 v44, v44, v47
v_cmp_ne_u32 vcc, 0, v44
s_cbranch_vccz L_allqok
s_add_u32 s66, s66, 1
s_sleep 8
s_cmp_lt_u32 s66, 200000
s_cbranch_scc1 L_allq
L_allqok:
s_cmp_eq_u32 s49, 0
s_cbranch_scc0 L_notag_41
s_mov_b32 s52, 32768
s_mov_b64 exec, 1
buffer_store_dword v17, v16, s[36:39], s52 offen sc1
s_mov_b64 exec, -1
L_notag_41:
v_lshlrev_b32 v10, 4, v0
s_mov_b32 s66, 0
L_fpoll:
s_lshl_b32 s52, s49, 15
s_add_u32 s52, s52, 2359296
buffer_load_dwordx4 v[96:99], v10, s[36:39], s52 offen offset:0 sc1
buffer_load_dwordx4 v[100:103], v10, s[36:39], s52 offen offset:1024 sc1
buffer_load_dwordx4 v[104:107], v10, s[36:39], s52 offen offset:2048 sc1
buffer_load_dwordx4 v[108:111], v10, s[36:39], s52 offen offset:3072 sc1
s_add_u32 s52, s52, 4096
buffer_load_dwordx4 v[112:115], v10, s[36:39], s52 offen offset:0 sc1
buffer_load_dwordx4 v[116:119], v10, s[36:39], s52 offen offset:1024 sc1
buffer_load_dwordx4 v[120:123], v10, s[36:39], s52 offen offset:2048 sc1
buffer_load_dwordx4 v[124:127], v10, s[36:39], s52 offen offset:3072 sc1
s_add_u32 s52, s52, 4096
buffer_load_dwordx4 v[128:131], v10, s[36:39], s52 offen offset:0 sc1
buffer_load_dwordx4 v[132:135], v10, s[36:39], s52 offen offset:1024 sc1
buffer_load_dwordx4 v[136:139], v10, s[36:39], s52 offen offset:2048 sc1
buffer_load_dwordx4 v[140:143], v10, s[36:39], s52 offen offset:3072 sc1
s_add_u32 s52, s52, 4096
buffer_load_dwordx4 v[144:147], v10, s[36:39], s52 offen offset:0 sc1
buffer_load_dwordx4 v[148:151], v10, s[36:39], s52 offen offset:1024 sc1
buffer_load_dwordx4 v[152:155], v10, s[36:39], s52 offen offset:2048 sc1
buffer_load_dwordx4 v[156:159], v10, s[36:39], s52 offen offset:3072 sc1
s_add_u32 s52, s52, 4096
buffer_load_dwordx4 v[160:163], v10, s[36:39], s52 offen offset:0 sc1
buffer_load_dwordx4 v[164:167], v10, s[36:39], s52 offen offset:1024 sc1
buffer_load_dwordx4 v[168:171], v10, s[36:39], s52 offen offset:2048 sc1
buffer_load_dwordx4 v[172:175], v10, s[36:39], s52 offen offset:3072 sc1
s_add_u32 s52, s52, 4096
buffer_load_dwordx4 v[176:179], v10, s[36:39], s52 offen offset:0 sc1
buffer_load_dwordx4 v[180:183], v10, s[36:39], s52 offen offset:1024 sc1
buffer_load_dwordx4 v[184:187], v10, s[36:39], s52 offen offset:2048 sc1
buffer_load_dwordx4 v[188:191], v10, s[36:39], s52 offen offset:3072 sc1
s_add_u32 s52, s52, 4096
buffer_load_dwordx4 v[192:195], v10, s[36:39], s52 offen offset:0 sc1
buffer_load_dwordx4 v[196:199], v10, s[36:39], s52 offen offset:1024 sc1
buffer_load_dwordx4 v[200:203], v10, s[36:39], s52 offen offset:2048 sc1
buffer_load_dwordx4 v[204:207], v10, s[36:39], s52 offen offset:3072 sc1
s_add_u32 s52, s52, 4096
buffer_load_dwordx4 v[208:211], v10, s[36:39], s52 offen offset:0 sc1
buffer_load_dwordx4 v[212:215], v10, s[36:39], s52 offen offset:1024 sc1
buffer_load_dwordx4 v[216:219], v10, s[36:39], s52 offen offset:2048 sc1
buffer_load_dwordx4 v[220:223], v10, s[36:39], s52 offen offset:3072 sc1
s_waitcnt vmcnt(0)
v_max3_u32 v13, v96, v97, v98
v_max3_u32 v13, v13, v99, v100
v_max3_u32 v13, v13, v101, v102
v_max3_u32 v13, v13, v103, v104
v_max3_u32 v13, v13, v105, v106
v_max3_u32 v13, v13, v107, v108
v_max3_u32 v13, v13, v109, v110
v_max3_u32 v13, v13, v111, v112
v_max3_u32 v13, v13, v113, v114
v_max3_u32 v13, v13, v115, v116
v_max3_u32 v13, v13, v117, v118
v_max3_u32 v13, v13, v119, v120
v_max3_u32 v13, v13, v121, v122
v_max3_u32 v13, v13, v123, v124
v_max3_u32 v13, v13, v125, v126
v_max3_u32 v13, v13, v127, v128
v_max3_u32 v13, v13, v129, v130
v_max3_u32 v13, v13, v131, v132
v_max3_u32 v13, v13, v133, v134
v_max3_u32 v13, v13, v135, v136
v_max3_u32 v13, v13, v137, v138
v_max3_u32 v13, v13, v139, v140
v_max3_u32 v13, v13, v141, v142
v_max3_u32 v13, v13, v143, v144
v_max3_u32 v13, v13, v145, v146
v_max3_u32 v13, v13, v147, v148
v_max3_u32 v13, v13, v149, v150
v_max3_u32 v13, v13, v151, v152
v_max3_u32 v13, v13, v153, v154
v_max3_u32 v13, v13, v155, v156
v_max3_u32 v13, v13, v157, v158
v_max3_u32 v13, v13, v159, v160
v_max3_u32 v13, v13, v161, v162
v_max3_u32 v13, v13, v163, v164
v_max3_u32 v13, v13, v165, v166
v_max3_u32 v13, v13, v167, v168
v_max3_u32 v13, v13, v169, v170
v_max3_u32 v13, v13, v171, v172
v_max3_u32 v13, v13, v173, v174
v_max3_u32 v13, v13, v175, v176
v_max3_u32 v13, v13, v177, v178
v_max3_u32 v13, v13, v179, v180
v_max3_u32 v13, v13, v181, v182
v_max3_u32 v13, v13, v183, v184
v_max3_u32 v13, v13, v185, v186
v_max3_u32 v13, v13, v187, v188
v_max3_u32 v13, v13, v189, v190
v_max3_u32 v13, v13, v191, v192
v_max3_u32 v13, v13, v193, v194
v_max3_u32 v13, v13, v195, v196
v_max3_u32 v13, v13, v197, v198
v_max3_u32 v13, v13, v199, v200
v_max3_u32 v13, v13, v201, v202
v_max3_u32 v13, v13, v203, v204
v_max3_u32 v13, v13, v205, v206
v_max3_u32 v13, v13, v207, v208
v_max3_u32 v13, v13, v209, v210
v_max3_u32 v13, v13, v211, v212
v_max3_u32 v13, v13, v213, v214
v_max3_u32 v13, v13, v215, v216
v_max3_u32 v13, v13, v217, v218
v_max3_u32 v13, v13, v219, v220
v_max3_u32 v13, v13, v221, v222
v_max_u32 v13, v13, v223
v_cmp_eq_u32 vcc, -1, v13
s_cbranch_vccz L_fok
s_add_u32 s66, s66, 1
s_sleep 32
s_cmp_lt_u32 s66, 200000
s_cbranch_scc1 L_fpoll
L_fok:
v_add_f32 v96, v96, v100
v_add_f32 v97, v97, v101
v_add_f32 v98, v98, v102
v_add_f32 v99, v99, v103
v_add_f32 v104, v104, v108
v_add_f32 v105, v105, v109
v_add_f32 v106, v106, v110
v_add_f32 v107, v107, v111
v_add_f32 v112, v112, v116
v_add_f32 v113, v113, v117
v_add_f32 v114, v114, v118
v_add_f32 v115, v115, v119
v_add_f32 v120, v120, v124
v_add_f32 v121, v121, v125
v_add_f32 v122, v122, v126
v_add_f32 v123, v123, v127
v_add_f32 v128, v128, v132
v_add_f32 v129, v129, v133
v_add_f32 v130, v130, v134
v_add_f32 v131, v131, v135
v_add_f32 v136, v136, v140
v_add_f32 v137, v137, v141
v_add_f32 v138, v138, v142
v_add_f32 v139, v139, v143
v_add_f32 v144, v144, v148
v_add_f32 v145, v145, v149
v_add_f32 v146, v146, v150
v_add_f32 v147, v147, v151
v_add_f32 v152, v152, v156
v_add_f32 v153, v153, v157
v_add_f32 v154, v154, v158
v_add_f32 v155, v155, v159
v_add_f32 v160, v160, v164
v_add_f32 v161, v161, v165
v_add_f32 v162, v162, v166
v_add_f32 v163, v163, v167
v_add_f32 v168, v168, v172
v_add_f32 v169, v169, v173
v_add_f32 v170, v170, v174
v_add_f32 v171, v171, v175
v_add_f32 v176, v176, v180
v_add_f32 v177, v177, v181
v_add_f32 v178, v178, v182
v_add_f32 v179, v179, v183
v_add_f32 v184, v184, v188
v_add_f32 v185, v185, v189
v_add_f32 v186, v186, v190
v_add_f32 v187, v187, v191
v_add_f32 v192, v192, v196
v_add_f32 v193, v193, v197
v_add_f32 v194, v194, v198
v_add_f32 v195, v195, v199
v_add_f32 v200, v200, v204
v_add_f32 v201, v201, v205
v_add_f32 v202, v202, v206
v_add_f32 v203, v203, v207
v_add_f32 v208, v208, v212
v_add_f32 v209, v209, v213
v_add_f32 v210, v210, v214
v_add_f32 v211, v211, v215
v_add_f32 v216, v216, v220
v_add_f32 v217, v217, v221
v_add_f32 v218, v218, v222
v_add_f32 v219, v219, v223
v_add_f32 v96, v96, v104
v_add_f32 v97, v97, v105
v_add_f32 v98, v98, v106
v_add_f32 v99, v99, v107
v_add_f32 v112, v112, v120
v_add_f32 v113, v113, v121
v_add_f32 v114, v114, v122
v_add_f32 v115, v115, v123
v_add_f32 v128, v128, v136
v_add_f32 v129, v129, v137
v_add_f32 v130, v130, v138
v_add_f32 v131, v131, v139
v_add_f32 v144, v144, v152
v_add_f32 v145, v145, v153
v_add_f32 v146, v146, v154
v_add_f32 v147, v147, v155
v_add_f32 v160, v160, v168
v_add_f32 v161, v161, v169
v_add_f32 v162, v162, v170
v_add_f32 v163, v163, v171
v_add_f32 v176, v176, v184
v_add_f32 v177, v177, v185
v_add_f32 v178, v178, v186
v_add_f32 v179, v179, v187
v_add_f32 v192, v192, v200
v_add_f32 v193, v193, v201
v_add_f32 v194, v194, v202
v_add_f32 v195, v195, v203
v_add_f32 v208, v208, v216
v_add_f32 v209, v209, v217
v_add_f32 v210, v210, v218
v_add_f32 v211, v211, v219
v_add_f32 v96, v96, v112
v_add_f32 v97, v97, v113
v_add_f32 v98, v98, v114
v_add_f32 v99, v99, v115
v_add_f32 v128, v128, v144
v_add_f32 v129, v129, v145
v_add_f32 v130, v130, v146
v_add_f32 v131, v131, v147
v_add_f32 v160, v160, v176
v_add_f32 v161, v161, v177
v_add_f32 v162, v162, v178
v_add_f32 v163, v163, v179
v_add_f32 v192, v192, v208
v_add_f32 v193, v193, v209
v_add_f32 v194, v194, v210
v_add_f32 v195, v195, v211
v_add_f32 v96, v96, v128
v_add_f32 v97, v97, v129
v_add_f32 v98, v98, v130
v_add_f32 v99, v99, v131
v_add_f32 v160, v160, v192
v_add_f32 v161, v161, v193
v_add_f32 v162, v162, v194
v_add_f32 v163, v163, v195
v_add_f32 v96, v96, v160
v_add_f32 v97, v97, v161
v_add_f32 v98, v98, v162
v_add_f32 v99, v99, v163
v_mov_b32 v24, v96
v_mov_b32 v25, v97
v_mov_b32 v26, v98
v_mov_b32 v27, v99
v_cvt_pk_bf16_f32 v19, v24, v25
v_lshlrev_b32 v24, 16, v19
v_and_b32 v25, 0xffff0000, v19
v_cvt_pk_bf16_f32 v19, v26, v27
v_lshlrev_b32 v26, 16, v19
v_and_b32 v27, 0xffff0000, v19
v_mul_f32 v50, 0xbfb8aa3b, v24
v_exp_f32 v50, v50
s_nop 0
v_add_f32 v50, 1.0, v50
v_rcp_f32 v50, v50
s_nop 0
v_mul_f32 v24, v24, v50
v_mul_f32 v50, 0xbfb8aa3b, v25
v_exp_f32 v50, v50
s_nop 0
v_add_f32 v50, 1.0, v50
v_rcp_f32 v50, v50
s_nop 0
v_mul_f32 v25, v25, v50
v_mul_f32 v50, 0xbfb8aa3b, v26
v_exp_f32 v50, v50
s_nop 0
v_add_f32 v50, 1.0, v50
v_rcp_f32 v50, v50
s_nop 0
v_mul_f32 v26, v26, v50
v_mul_f32 v50, 0xbfb8aa3b, v27
v_exp_f32 v50, v50
s_nop 0
v_add_f32 v50, 1.0, v50
v_rcp_f32 v50, v50
s_nop 0
v_mul_f32 v27, v27, v50
v_cvt_pk_bf16_f32 v19, v24, v25
v_lshlrev_b32 v24, 16, v19
v_and_b32 v25, 0xffff0000, v19
v_cvt_pk_bf16_f32 v19, v26, v27
v_lshlrev_b32 v26, 16, v19
v_and_b32 v27, 0xffff0000, v19
s_mov_b32 s40, s4
s_and_b32 s41, s5, 0xffff
s_mov_b32 s42, 2560
s_mov_b32 s43, 0x20000
v_lshrrev_b32 v10, 5, v0
v_mul_u32_u24 v10, 1280, v10
v_and_b32 v11, 31, v0
v_lshl_add_u32 v10, v11, 3, v10
s_lshl_b32 s52, s49, 8
v_add_u32 v12, s52, v10
buffer_load_dwordx2 v[32:33], v12, s[40:43], 0 offen
s_waitcnt vmcnt(0)
v_lshlrev_b32 v28, 16, v32
v_and_b32 v29, 0xffff0000, v32
v_lshlrev_b32 v30, 16, v33
v_and_b32 v31, 0xffff0000, v33
L_nofinprep:
s_cmp_ge_u32 s49, 5
s_cbranch_scc1 L_nowo
v_mov_b32 v14, 3584
s_mov_b32 s44, s12
s_and_b32 s45, s13, 0xffff
s_mov_b32 s46, 7864320
s_mov_b32 s47, 0x20000
v_lshlrev_b32 v15, 1, v7
v_xor_b32 v15, v15, v6
v_mul_u32_u24 v11, 1280, v7
v_lshl_add_u32 v11, v15, 4, v11
v_xor_b32 v15, 0x80, v11
s_mul_i32 s53, s48, 245760
s_lshl_b32 s54, s49, 8
s_add_u32 s53, s53, s54
L_wowait:
ds_read_b32 v13, v14
s_waitcnt lgkmcnt(0)
v_readfirstlane_b32 s52, v13
s_nop 1
s_cmp_lg_u32 s52, 0
s_cbranch_scc1 L_wogo
s_sleep 4
s_branch L_wowait
L_wogo:
s_mov_b32 m0, 53248
s_nop 0
buffer_load_dwordx4 v11, s[44:47], s53 offen nt lds
s_add_u32 s53, s53, 5120
s_mov_b32 m0, 54272
s_nop 0
buffer_load_dwordx4 v11, s[44:47], s53 offen nt lds
s_add_u32 s53, s53, 5120
s_mov_b32 m0, 55296
s_nop 0
buffer_load_dwordx4 v15, s[44:47], s53 offen nt lds
s_add_u32 s53, s53, 5120
s_mov_b32 m0, 56320
s_nop 0
buffer_load_dwordx4 v15, s[44:47], s53 offen nt lds
s_add_u32 s53, s53, 5120
s_mov_b32 m0, 57344
s_nop 0
buffer_load_dwordx4 v11, s[44:47], s53 offen nt lds
s_add_u32 s53, s53, 5120
s_mov_b32 m0, 58368
s_nop 0
buffer_load_dwordx4 v11, s[44:47], s53 offen nt lds
s_add_u32 s53, s53, 5120
s_mov_b32 m0, 59392
s_nop 0
buffer_load_dwordx4 v15, s[44:47], s53 offen nt lds
s_add_u32 s53, s53, 5120
s_mov_b32 m0, 60416
s_nop 0
buffer_load_dwordx4 v15, s[44:47], s53 offen nt lds
s_add_u32 s53, s53, 5120
s_mov_b32 m0, 61440
s_nop 0
buffer_load_dwordx4 v11, s[44:47], s53 offen nt lds
s_add_u32 s53, s53, 5120
s_mov_b32 m0, 62464
s_nop 0
buffer_load_dwordx4 v11, s[44:47], s53 offen nt lds
s_add_u32 s53, s53, 5120
s_mov_b32 m0, 63488
s_nop 0
buffer_load_dwordx4 v15, s[44:47], s53 offen nt lds
s_add_u32 s53, s53, 5120
s_mov_b32 m0, 64512
s_nop 0
buffer_load_dwordx4 v15, s[44:47], s53 offen nt lds
s_add_u32 s53, s53, 5120
s_mov_b32 m0, 65536
s_nop 0
buffer_load_dwordx4 v11, s[44:47], s53 offen nt lds
s_add_u32 s53, s53, 5120
s_mov_b32 m0, 66560
s_nop 0
buffer_load_dwordx4 v11, s[44:47], s53 offen nt lds
s_add_u32 s53, s53, 5120
s_mov_b32 m0, 67584
s_nop 0
buffer_load_dwordx4 v15, s[44:47], s53 offen nt lds
s_add_u32 s53, s53, 5120
s_mov_b32 m0, 68608
s_nop 0
buffer_load_dwordx4 v15, s[44:47], s53 offen nt lds
s_add_u32 s53, s53, 5120
s_mov_b32 m0, 69632
s_nop 0
buffer_load_dwordx4 v11, s[44:47], s53 offen nt lds
s_add_u32 s53, s53, 5120
s_mov_b32 m0, 70656
s_nop 0
buffer_load_dwordx4 v11, s[44:47], s53 offen nt lds
s_add_u32 s53, s53, 5120
s_mov_b32 m0, 71680
s_nop 0
buffer_load_dwordx4 v15, s[44:47], s53 offen nt lds
s_add_u32 s53, s53, 5120
s_mov_b32 m0, 72704
s_nop 0
buffer_load_dwordx4 v15, s[44:47], s53 offen nt lds
s_add_u32 s53, s53, 5120
s_mov_b32 m0, 73728
s_nop 0
buffer_load_dwordx4 v11, s[44:47], s53 offen nt lds
s_add_u32 s53, s53, 5120
s_mov_b32 m0, 74752
s_nop 0
buffer_load_dwordx4 v11, s[44:47], s53 offen nt lds
s_add_u32 s53, s53, 5120
s_mov_b32 m0, 75776
s_nop 0
buffer_load_dwordx4 v15, s[44:47], s53 offen nt lds
s_add_u32 s53, s53, 5120
s_mov_b32 m0, 76800
s_nop 0
buffer_load_dwordx4 v15, s[44:47], s53 offen nt lds
s_add_u32 s53, s53, 5120
s_mov_b32 m0, 77824
s_nop 0
buffer_load_dwordx4 v11, s[44:47], s53 offen nt lds
s_add_u32 s53, s53, 5120
s_mov_b32 m0, 78848
s_nop 0
buffer_load_dwordx4 v11, s[44:47], s53 offen nt lds
s_add_u32 s53, s53, 5120
s_mov_b32 m0, 79872
s_nop 0
buffer_load_dwordx4 v15, s[44:47], s53 offen nt lds
s_add_u32 s53, s53, 5120
s_mov_b32 m0, 80896
s_nop 0
buffer_load_dwordx4 v15, s[44:47], s53 offen nt lds
s_add_u32 s53, s53, 5120
s_mov_b32 m0, 81920
s_nop 0
buffer_load_dwordx4 v11, s[44:47], s53 offen nt lds
s_add_u32 s53, s53, 5120
s_mov_b32 m0, 82944
s_nop 0
buffer_load_dwordx4 v11, s[44:47], s53 offen nt lds
s_add_u32 s53, s53, 5120
s_mov_b32 m0, 83968
s_nop 0
buffer_load_dwordx4 v15, s[44:47], s53 offen nt lds
s_add_u32 s53, s53, 5120
s_mov_b32 m0, 84992
s_nop 0
buffer_load_dwordx4 v15, s[44:47], s53 offen nt lds
s_add_u32 s53, s53, 5120
s_mov_b32 m0, 86016
s_nop 0
buffer_load_dwordx4 v11, s[44:47], s53 offen nt lds
s_add_u32 s53, s53, 5120
s_mov_b32 m0, 87040
s_nop 0
buffer_load_dwordx4 v11, s[44:47], s53 offen nt lds
s_add_u32 s53, s53, 5120
s_mov_b32 m0, 88064
s_nop 0
buffer_load_dwordx4 v15, s[44:47], s53 offen nt lds
s_add_u32 s53, s53, 5120
s_mov_b32 m0, 89088
s_nop 0
buffer_load_dwordx4 v15, s[44:47], s53 offen nt lds
s_add_u32 s53, s53, 5120
s_mov_b32 m0, 90112
s_nop 0
buffer_load_dwordx4 v11, s[44:47], s53 offen nt lds
s_add_u32 s53, s53, 5120
s_mov_b32 m0, 91136
s_nop 0
buffer_load_dwordx4 v11, s[44:47], s53 offen nt lds
s_add_u32 s53, s53, 5120
s_mov_b32 m0, 92160
s_nop 0
buffer_load_dwordx4 v15, s[44:47], s53 offen nt lds
s_add_u32 s53, s53, 5120
s_mov_b32 m0, 93184
s_nop 0
buffer_load_dwordx4 v15, s[44:47], s53 offen nt lds
s_add_u32 s53, s53, 5120
s_mov_b32 m0, 94208
s_nop 0
buffer_load_dwordx4 v11, s[44:47], s53 offen nt lds
s_add_u32 s53, s53, 5120
s_mov_b32 m0, 95232
s_nop 0
buffer_load_dwordx4 v11, s[44:47], s53 offen nt lds
s_add_u32 s53, s53, 5120
s_mov_b32 m0, 96256
s_nop 0
buffer_load_dwordx4 v15, s[44:47], s53 offen nt lds
s_add_u32 s53, s53, 5120
s_mov_b32 m0, 97280
s_nop 0
buffer_load_dwordx4 v15, s[44:47], s53 offen nt lds
s_add_u32 s53, s53, 5120
s_mov_b32 m0, 98304
s_nop 0
buffer_load_dwordx4 v11, s[44:47], s53 offen nt lds
s_add_u32 s53, s53, 5120
s_mov_b32 m0, 99328
s_nop 0
buffer_load_dwordx4 v11, s[44:47], s53 offen nt lds
s_add_u32 s53, s53, 5120
s_mov_b32 m0, 100352
s_nop 0
buffer_load_dwordx4 v15, s[44:47], s53 offen nt lds
s_add_u32 s53, s53, 5120
s_mov_b32 m0, 101376
s_nop 0
buffer_load_dwordx4 v15, s[44:47], s53 offen nt lds
L_nowo:
s_barrier
s_cmp_ge_u32 s49, 5
s_cbranch_scc1 L_fin_helper
s_waitcnt vmcnt(0)
s_barrier
s_barrier
s_cmp_eq_u32 s69, 0
s_cbranch_scc1 L_fin_helper
s_barrier
v_lshlrev_b32 v10, 4, v0
ds_read_b128 v[96:99], v10 offset:11264
ds_read_b128 v[100:103], v10 offset:12288
ds_read_b128 v[104:107], v10 offset:13312
ds_read_b128 v[108:111], v10 offset:14336
s_mov_b32 s40, s22
s_and_b32 s41, s23, 0xffff
s_mov_b32 s42, 2560
s_mov_b32 s43, 0x20000
s_waitcnt lgkmcnt(0)
v_add_f32 v96, v96, v100
v_add_f32 v104, v104, v108
v_add_f32 v97, v97, v101
v_add_f32 v105, v105, v109
v_add_f32 v98, v98, v102
v_add_f32 v106, v106, v110
v_add_f32 v99, v99, v103
v_add_f32 v107, v107, v111
v_add_f32 v96, v96, v104
v_add_f32 v97, v97, v105
v_add_f32 v98, v98, v106
v_add_f32 v99, v99, v107
v_cvt_pk_bf16_f32 v19, v96, v97
v_lshlrev_b32 v96, 16, v19
v_and_b32 v97, 0xffff0000, v19
v_cvt_pk_bf16_f32 v19, v98, v99
v_lshlrev_b32 v98, 16, v19
v_and_b32 v99, 0xffff0000, v19
v_mul_f32 v96, v96, v24
v_mul_f32 v97, v97, v25
v_mul_f32 v98, v98, v26
v_mul_f32 v99, v99, v27
v_cvt_pk_bf16_f32 v19, v96, v97
v_lshlrev_b32 v96, 16, v19
v_and_b32 v97, 0xffff0000, v19
v_cvt_pk_bf16_f32 v19, v98, v99
v_lshlrev_b32 v98, 16, v19
v_and_b32 v99, 0xffff0000, v19
v_add_f32 v96, v96, v28
v_add_f32 v97, v97, v29
v_add_f32 v98, v98, v30
v_add_f32 v99, v99, v31
v_cvt_pk_bf16_f32 v96, v96, v97
v_cvt_pk_bf16_f32 v97, v98, v99
buffer_store_dwordx2 v[96:97], v12, s[40:43], 0 offen
L_fin_helper:
L_end:
s_endpgm
.section .rodata,"a"
.p2align 6
.amdhsa_kernel recurrent_scan__mha_block_cached__swiglu_ffn__decode_kernel
.amdhsa_next_free_vgpr 224
.amdhsa_next_free_sgpr 102
.amdhsa_accum_offset 224
.amdhsa_group_segment_fixed_size 0
.amdhsa_kernarg_size 96
.amdhsa_user_sgpr_count 2
.amdhsa_user_sgpr_kernarg_segment_ptr 1
.amdhsa_system_sgpr_workgroup_id_x 1
.end_amdhsa_kernel
```
